```python
import torch

def _softmax(x, axis=-1):
    return torch.softmax(x, dim=axis)
def _gelu(x):
    return torch.nn.functional.gelu(x, approximate="tanh")
def _silu(x):
    return torch.nn.functional.silu(x)
def _sigmoid(x):
    return torch.sigmoid(x)
def _layernorm(x, axis=-1, eps=1e-5):
    m = x.mean(dim=axis, keepdim=True)
    v = x.var(dim=axis, keepdim=True, unbiased=False)
    return (x - m) / torch.sqrt(v + eps)
def _scatter_add(tgt, idx, src, axis=0):
    return tgt.clone().index_add_(axis, idx, src)
def _segment_sum(src, seg, n):
    out = torch.zeros((n,) + src.shape[1:], dtype=src.dtype)
    return out.index_add_(0, seg, src)
def _pad(x, pw):
    flat = tuple(v for pair in reversed(pw) for v in pair)
    return torch.nn.functional.pad(x, flat)

kernel_name = 'sequential_preLN__mha_block_cached__glu_gated_geglu__decode'

def setup_inputs():

    _w = (lambda a: (lambda t: t.to(torch.bfloat16) if t.is_floating_point() else t)(torch.as_tensor(a)))
    def _A_setup():
        B, Sq, D = 1, 1, 576
        H, Sk, Dh = 32, 16384, 128
        return {
            "x": _w((lambda *s: torch.randn(*s, dtype=torch.bfloat16) * 0.05)(B, Sq, D)),
            "k_cache": _w((lambda *s: torch.randn(*s, dtype=torch.bfloat16) * 3.2)(B, H, Sk, Dh)),
            "v_cache": _w((lambda *s: torch.randn(*s, dtype=torch.bfloat16) * 1.6)(B, H, Sk, Dh)),
            "wq": _w((lambda *s: torch.randn(*s, dtype=torch.bfloat16) * 3.2)(D, H * Dh) * (D ** -0.5)),
            "wo": _w((lambda *s: torch.randn(*s, dtype=torch.bfloat16) * 1.6)(H * Dh, D) * ((H * Dh) ** -0.5)),
        }
    _A_in = _A_setup()

    def _B_setup():
        B, S, Dm, Df = 1, 1, 576, 4608
        return {
            "x": _w((lambda *s: torch.randn(*s, dtype=torch.bfloat16) * 0.05)(B, S, Dm)),
            "w_gate": _w((lambda *s: torch.randn(*s, dtype=torch.bfloat16) * 1.6)(Dm, Df) * (Dm ** -0.5)),
            "w_up": _w((lambda *s: torch.randn(*s, dtype=torch.bfloat16) * 1.6)(Dm, Df) * (Dm ** -0.5)),
            "w_down": _w((lambda *s: torch.randn(*s, dtype=torch.bfloat16) * 1.6)(Df, Dm) * (Df ** -0.5)),
        }
    _B_in = _B_setup()

    return {
        "A_x": _A_in["x"],
        "A_k_cache": _A_in["k_cache"],
        "A_v_cache": _A_in["v_cache"],
        "A_wq": _A_in["wq"],
        "A_wo": _A_in["wo"],
        "B_x": _B_in["x"],
        "B_w_gate": _B_in["w_gate"],
        "B_w_up": _B_in["w_up"],
        "B_w_down": _B_in["w_down"],
    }

def reference(A_x, A_k_cache, A_v_cache, A_wq, A_wo, B_x, B_w_gate, B_w_up, B_w_down):
    def _A_ref(x, k_cache, v_cache, wq, wo):
        B, Sq, D = x.shape
        H, Dh = 32, 128
        q = (lambda x, *d: x.permute(*d))((x @ wq).reshape(B, Sq, H, Dh), 0, 2, 1, 3)
        scores = torch.einsum("bhqd,bhkd->bhqk", q, k_cache) * (Dh ** -0.5)
        p = _softmax(scores, axis=-1)
        o = torch.einsum("bhqk,bhkd->bhqd", p, v_cache)
        return (lambda x, *d: x.permute(*d))(o, 0, 2, 1, 3).reshape(B, Sq, H * Dh) @ wo

    def _B_ref(x, w_gate, w_up, w_down):
        g = torch.einsum("bsd,df->bsf", x, w_gate)
        u = torch.einsum("bsd,df->bsf", x, w_up)
        h = _gelu(g) * u
        return torch.einsum("bsf,fd->bsd", h, w_down)

    x = A_x
    h = x + _A_ref(_layernorm(x, axis=-1), A_k_cache, A_v_cache, A_wq, A_wo)
    h2 = h + _B_ref(_layernorm(h, axis=-1), B_w_gate, B_w_up, B_w_down)
    return h2
```

```asm
; @launch grid=(256,1,1) block=(512,1,1) lds=32768
.amdgcn_target "amdgcn-amd-amdhsa--gfx950"
.text
.globl sequential_preLN__mha_block_cached__glu_gated_geglu__decode_kernel
.p2align 8
.type sequential_preLN__mha_block_cached__glu_gated_geglu__decode_kernel,@function
sequential_preLN__mha_block_cached__glu_gated_geglu__decode_kernel:
    s_cmp_ge_u32 s2, 256
    s_cbranch_scc1 L_end
    s_load_dwordx16 s[4:19], s[0:1], 0
    s_load_dwordx8 s[20:27], s[0:1], 64
    v_lshrrev_b32 v1, 6, v0
    v_and_b32 v2, 63, v0
    v_mov_b32 v37, 0
    v_readfirstlane_b32 s3, v1
    v_lshlrev_b32 v3, 2, v2
    ds_write_b32 v3, v37 offset:2560
    s_and_b32 s73, s2, 7
    s_lshr_b32 s82, s2, 3
    s_lshl_b32 s83, s73, 2
    s_add_u32 s82, s82, s83
    s_and_b32 s68, s82, 31
    s_lshl_b32 s83, s73, 5
    s_add_u32 s69, s83, s68
    v_lshlrev_b32 v1, 4, v2
    v_lshrrev_b32 v34, 4, v2
    v_and_b32 v35, 15, v2
    v_mov_b32 v36, 0x7fff0000
    s_and_b32 s88, s3, 3
    s_lshl_b32 s82, s68, 22
    s_mul_i32 s90, s73, 425984
    s_lshl_b32 s83, s3, 12
    s_add_u32 s90, s90, s83
    s_waitcnt lgkmcnt(0)
    s_barrier
    s_cmp_ge_u32 s3, 4
    s_cbranch_scc1 L_helper
    s_add_u32 s6, s6, s82
    s_addc_u32 s7, s7, 0
    s_add_u32 s8, s8, s82
    s_addc_u32 s9, s9, 0
    s_mov_b32 s28, s6
    s_and_b32 s29, s7, 0xffff
    s_mov_b32 s30, 0x400000
    s_mov_b32 s31, 0x20000
    s_mov_b32 s32, s8
    s_and_b32 s33, s9, 0xffff
    s_mov_b32 s34, 0x400000
    s_mov_b32 s35, 0x20000
    s_add_u32 s91, s90, 16384
    s_add_u32 s92, s90, 32768
    s_add_u32 s93, s90, 49152
    s_add_u32 s94, s90, 65536
    s_add_u32 s95, s90, 81920
    s_mov_b32 s77, 0x3fb8aa3b
    s_mov_b32 s79, 0xffff0000
    v_lshlrev_b32 v38, 5, v35
    v_lshl_add_u32 v38, v34, 3, v38
    s_lshl_b32 s83, s88, 9
    v_add_u32 v38, s83, v38
    v_lshlrev_b32 v39, 3, v2
    s_mov_b32 s44, s26
    s_and_b32 s45, s27, 0xffff
    s_mov_b32 s46, 0x200000
    s_mov_b32 s47, 0x20000
    buffer_atomic_add v233, v36, s[44:47], 0 offen sc0 sc1
    buffer_load_dwordx4 v[168:171], v1, s[28:31], s94 offen offset:0 nt
    buffer_load_dwordx4 v[172:175], v1, s[28:31], s94 offen offset:1024 nt
    buffer_load_dwordx4 v[176:179], v1, s[28:31], s94 offen offset:2048 nt
    buffer_load_dwordx4 v[180:183], v1, s[28:31], s94 offen offset:3072 nt
    buffer_load_dwordx4 v[184:187], v1, s[32:35], s94 offen offset:0 nt
    buffer_load_dwordx4 v[188:191], v1, s[32:35], s94 offen offset:1024 nt
    buffer_load_dwordx4 v[192:195], v1, s[32:35], s94 offen offset:2048 nt
    buffer_load_dwordx4 v[196:199], v1, s[32:35], s94 offen offset:3072 nt
    buffer_atomic_add v234, v36, s[44:47], 0 offen sc0 sc1
    buffer_load_dwordx4 v[200:203], v1, s[28:31], s95 offen offset:0 nt
    buffer_load_dwordx4 v[204:207], v1, s[28:31], s95 offen offset:1024 nt
    buffer_load_dwordx4 v[208:211], v1, s[28:31], s95 offen offset:2048 nt
    buffer_load_dwordx4 v[212:215], v1, s[28:31], s95 offen offset:3072 nt
    buffer_load_dwordx4 v[216:219], v1, s[32:35], s95 offen offset:0 nt
    buffer_load_dwordx4 v[220:223], v1, s[32:35], s95 offen offset:1024 nt
    buffer_load_dwordx4 v[224:227], v1, s[32:35], s95 offen offset:2048 nt
    buffer_load_dwordx4 v[228:231], v1, s[32:35], s95 offen offset:3072 nt
    s_waitcnt vmcnt(12)
    buffer_load_dwordx4 v[40:43], v1, s[28:31], s90 offen offset:0 nt
    buffer_load_dwordx4 v[44:47], v1, s[28:31], s90 offen offset:1024 nt
    buffer_load_dwordx4 v[48:51], v1, s[28:31], s90 offen offset:2048 nt
    buffer_load_dwordx4 v[52:55], v1, s[28:31], s90 offen offset:3072 nt
    s_waitcnt vmcnt(12)
    buffer_load_dwordx4 v[56:59], v1, s[32:35], s90 offen offset:0 nt
    buffer_load_dwordx4 v[60:63], v1, s[32:35], s90 offen offset:1024 nt
    buffer_load_dwordx4 v[64:67], v1, s[32:35], s90 offen offset:2048 nt
    buffer_load_dwordx4 v[68:71], v1, s[32:35], s90 offen offset:3072 nt
    s_waitcnt vmcnt(12)
    buffer_load_dwordx4 v[72:75], v1, s[28:31], s91 offen offset:0 nt
    buffer_load_dwordx4 v[76:79], v1, s[28:31], s91 offen offset:1024 nt
    buffer_load_dwordx4 v[80:83], v1, s[28:31], s91 offen offset:2048 nt
    buffer_load_dwordx4 v[84:87], v1, s[28:31], s91 offen offset:3072 nt
    s_waitcnt vmcnt(12)
    buffer_load_dwordx4 v[88:91], v1, s[32:35], s91 offen offset:0 nt
    buffer_load_dwordx4 v[92:95], v1, s[32:35], s91 offen offset:1024 nt
    buffer_load_dwordx4 v[96:99], v1, s[32:35], s91 offen offset:2048 nt
    buffer_load_dwordx4 v[100:103], v1, s[32:35], s91 offen offset:3072 nt
    s_waitcnt vmcnt(12)
    buffer_load_dwordx4 v[104:107], v1, s[28:31], s92 offen offset:0 nt
    buffer_load_dwordx4 v[108:111], v1, s[28:31], s92 offen offset:1024 nt
    buffer_load_dwordx4 v[112:115], v1, s[28:31], s92 offen offset:2048 nt
    buffer_load_dwordx4 v[116:119], v1, s[28:31], s92 offen offset:3072 nt
    s_waitcnt vmcnt(12)
    buffer_load_dwordx4 v[120:123], v1, s[32:35], s92 offen offset:0 nt
    buffer_load_dwordx4 v[124:127], v1, s[32:35], s92 offen offset:1024 nt
    buffer_load_dwordx4 v[128:131], v1, s[32:35], s92 offen offset:2048 nt
    buffer_load_dwordx4 v[132:135], v1, s[32:35], s92 offen offset:3072 nt
    s_waitcnt vmcnt(12)
    buffer_load_dwordx4 v[136:139], v1, s[28:31], s93 offen offset:0 nt
    buffer_load_dwordx4 v[140:143], v1, s[28:31], s93 offen offset:1024 nt
    buffer_load_dwordx4 v[144:147], v1, s[28:31], s93 offen offset:2048 nt
    buffer_load_dwordx4 v[148:151], v1, s[28:31], s93 offen offset:3072 nt
    s_waitcnt vmcnt(12)
    buffer_load_dwordx4 v[152:155], v1, s[32:35], s93 offen offset:0 nt
    buffer_load_dwordx4 v[156:159], v1, s[32:35], s93 offen offset:1024 nt
    buffer_load_dwordx4 v[160:163], v1, s[32:35], s93 offen offset:2048 nt
    buffer_load_dwordx4 v[164:167], v1, s[32:35], s93 offen offset:3072 nt
    s_mov_b32 s78, 0x3db504f3
    v_mov_b32 v8, 0
    v_mov_b32 v9, 0
    v_mov_b32 v10, 0
    v_mov_b32 v11, 0
    v_mov_b32 v12, 0
    v_mov_b32 v13, 0
    v_mov_b32 v14, 0
    v_mov_b32 v15, 0
    v_mov_b32 v16, 0xff800000
    v_mov_b32 v17, 0
    v_lshlrev_b32 v27, 4, v35
    v_cmp_eq_u32 vcc, 0, v2
    s_nop 1
    v_cndmask_b32 v232, v36, v37, vcc
    s_lshl_b32 s99, s68, 10
    s_add_u32 s99, s99, 768
    s_mov_b32 s98, 6
    s_mov_b32 s74, 0x7fff0000
    s_mov_b32 s76, 0
L_qwait:
    ds_read_b32 v26, v37 offset:2564
    ds_read_b128 v[4:7], v27 offset:8192
    s_waitcnt lgkmcnt(0)
    v_readfirstlane_b32 s82, v26
    s_cmp_lg_u32 s82, 0
    s_nop 3
    s_cbranch_scc1 L_go
    s_add_u32 s76, s76, 1
    s_cmp_gt_u32 s76, 480000
    s_cbranch_scc1 L_go
    s_sleep 1
    s_branch L_qwait
L_go:
    s_waitcnt vmcnt(45)
    v_dot2_f32_bf16 v18, v168, v4, 0
    v_dot2_f32_bf16 v19, v172, v4, 0
    v_dot2_f32_bf16 v20, v176, v4, 0
    v_dot2_f32_bf16 v21, v180, v4, 0
    v_dot2_f32_bf16 v18, v169, v5, v18
    v_dot2_f32_bf16 v19, v173, v5, v19
    v_dot2_f32_bf16 v20, v177, v5, v20
    v_dot2_f32_bf16 v21, v181, v5, v21
    v_dot2_f32_bf16 v18, v170, v6, v18
    v_dot2_f32_bf16 v19, v174, v6, v19
    v_dot2_f32_bf16 v20, v178, v6, v20
    v_dot2_f32_bf16 v21, v182, v6, v21
    v_dot2_f32_bf16 v18, v171, v7, v18
    v_dot2_f32_bf16 v19, v175, v7, v19
    v_dot2_f32_bf16 v20, v179, v7, v20
    v_dot2_f32_bf16 v21, v183, v7, v21
    s_add_u32 s94, s94, 32768
    s_add_u32 s98, s98, 1
    buffer_atomic_add v233, v36, s[44:47], 0 offen sc0 sc1
    buffer_load_dwordx4 v[168:171], v1, s[28:31], s94 offen offset:0 nt
    buffer_load_dwordx4 v[172:175], v1, s[28:31], s94 offen offset:1024 nt
    buffer_load_dwordx4 v[176:179], v1, s[28:31], s94 offen offset:2048 nt
    buffer_load_dwordx4 v[180:183], v1, s[28:31], s94 offen offset:3072 nt
    v_add_f32_dpp v18, v18, v18 row_mirror row_mask:0xf bank_mask:0x3
    v_add_f32_dpp v19, v19, v19 row_mirror row_mask:0xf bank_mask:0x3
    s_nop 0
    v_add_f32_dpp v18, v20, v20 row_mirror row_mask:0xf bank_mask:0xc
    v_add_f32_dpp v19, v21, v21 row_mirror row_mask:0xf bank_mask:0xc
    s_nop 0
    v_add_f32_dpp v18, v18, v18 row_half_mirror row_mask:0xf bank_mask:0x5
    s_nop 1
    v_add_f32_dpp v18, v19, v19 row_half_mirror row_mask:0xf bank_mask:0xa
    s_nop 1
    v_add_f32_dpp v18, v18, v18 quad_perm:[1,0,3,2] row_mask:0xf bank_mask:0xf
    s_nop 1
    v_add_f32_dpp v18, v18, v18 quad_perm:[2,3,0,1] row_mask:0xf bank_mask:0xf
    v_cvt_pk_bf16_f32 v18, v18, v18
    v_and_b32 v18, s79, v18
    v_mul_f32 v18, s78, v18
    v_cvt_pk_bf16_f32 v18, v18, v18
    v_and_b32 v18, s79, v18
    v_max_f32 v20, v18, v16
    s_nop 1
    v_max_f32_dpp v20, v20, v20 row_half_mirror row_mask:0xf bank_mask:0xf
    s_nop 1
    v_max_f32_dpp v20, v20, v20 row_mirror row_mask:0xf bank_mask:0xf
    v_mov_b32 v21, v20
    s_nop 1
    v_permlane32_swap_b32 v20, v21
    v_max_f32 v20, v20, v21
    v_mov_b32 v21, v20
    s_nop 1
    v_permlane16_swap_b32 v20, v21
    v_max_f32 v20, v20, v21
    v_sub_f32 v21, v16, v20
    v_sub_f32 v18, v18, v20
    v_mov_b32 v16, v20
    v_mul_f32 v21, s77, v21
    v_mul_f32 v18, s77, v18
    v_exp_f32 v21, v21
    v_exp_f32 v18, v18
    v_mul_f32 v8, v8, v21
    v_mul_f32 v9, v9, v21
    v_mul_f32 v10, v10, v21
    v_mul_f32 v11, v11, v21
    v_mul_f32 v12, v12, v21
    v_mul_f32 v13, v13, v21
    v_mul_f32 v14, v14, v21
    v_mul_f32 v15, v15, v21
    v_fma_f32 v17, v17, v21, v18
    s_waitcnt vmcnt(49)
    v_lshlrev_b32 v26, 16, v184
    v_and_b32 v27, s79, v184
    v_lshlrev_b32 v28, 16, v185
    v_and_b32 v29, s79, v185
    v_lshlrev_b32 v30, 16, v186
    v_and_b32 v31, s79, v186
    v_lshlrev_b32 v32, 16, v187
    v_and_b32 v33, s79, v187
    v_fmac_f32_dpp v8, v18, v26 row_newbcast:0 row_mask:0xf bank_mask:0xf
    v_fmac_f32_dpp v9, v18, v27 row_newbcast:0 row_mask:0xf bank_mask:0xf
    v_fmac_f32_dpp v10, v18, v28 row_newbcast:0 row_mask:0xf bank_mask:0xf
    v_fmac_f32_dpp v11, v18, v29 row_newbcast:0 row_mask:0xf bank_mask:0xf
    v_fmac_f32_dpp v12, v18, v30 row_newbcast:0 row_mask:0xf bank_mask:0xf
    v_fmac_f32_dpp v13, v18, v31 row_newbcast:0 row_mask:0xf bank_mask:0xf
    v_fmac_f32_dpp v14, v18, v32 row_newbcast:0 row_mask:0xf bank_mask:0xf
    v_fmac_f32_dpp v15, v18, v33 row_newbcast:0 row_mask:0xf bank_mask:0xf
    s_waitcnt vmcnt(48)
    v_lshlrev_b32 v26, 16, v188
    v_and_b32 v27, s79, v188
    v_lshlrev_b32 v28, 16, v189
    v_and_b32 v29, s79, v189
    v_lshlrev_b32 v30, 16, v190
    v_and_b32 v31, s79, v190
    v_lshlrev_b32 v32, 16, v191
    v_and_b32 v33, s79, v191
    v_fmac_f32_dpp v8, v18, v26 row_newbcast:4 row_mask:0xf bank_mask:0xf
    v_fmac_f32_dpp v9, v18, v27 row_newbcast:4 row_mask:0xf bank_mask:0xf
    v_fmac_f32_dpp v10, v18, v28 row_newbcast:4 row_mask:0xf bank_mask:0xf
    v_fmac_f32_dpp v11, v18, v29 row_newbcast:4 row_mask:0xf bank_mask:0xf
    v_fmac_f32_dpp v12, v18, v30 row_newbcast:4 row_mask:0xf bank_mask:0xf
    v_fmac_f32_dpp v13, v18, v31 row_newbcast:4 row_mask:0xf bank_mask:0xf
    v_fmac_f32_dpp v14, v18, v32 row_newbcast:4 row_mask:0xf bank_mask:0xf
    v_fmac_f32_dpp v15, v18, v33 row_newbcast:4 row_mask:0xf bank_mask:0xf
    s_waitcnt vmcnt(47)
    v_lshlrev_b32 v26, 16, v192
    v_and_b32 v27, s79, v192
    v_lshlrev_b32 v28, 16, v193
    v_and_b32 v29, s79, v193
    v_lshlrev_b32 v30, 16, v194
    v_and_b32 v31, s79, v194
    v_lshlrev_b32 v32, 16, v195
    v_and_b32 v33, s79, v195
    v_fmac_f32_dpp v8, v18, v26 row_newbcast:8 row_mask:0xf bank_mask:0xf
    v_fmac_f32_dpp v9, v18, v27 row_newbcast:8 row_mask:0xf bank_mask:0xf
    v_fmac_f32_dpp v10, v18, v28 row_newbcast:8 row_mask:0xf bank_mask:0xf
    v_fmac_f32_dpp v11, v18, v29 row_newbcast:8 row_mask:0xf bank_mask:0xf
    v_fmac_f32_dpp v12, v18, v30 row_newbcast:8 row_mask:0xf bank_mask:0xf
    v_fmac_f32_dpp v13, v18, v31 row_newbcast:8 row_mask:0xf bank_mask:0xf
    v_fmac_f32_dpp v14, v18, v32 row_newbcast:8 row_mask:0xf bank_mask:0xf
    v_fmac_f32_dpp v15, v18, v33 row_newbcast:8 row_mask:0xf bank_mask:0xf
    s_waitcnt vmcnt(46)
    v_lshlrev_b32 v26, 16, v196
    v_and_b32 v27, s79, v196
    v_lshlrev_b32 v28, 16, v197
    v_and_b32 v29, s79, v197
    v_lshlrev_b32 v30, 16, v198
    v_and_b32 v31, s79, v198
    v_lshlrev_b32 v32, 16, v199
    v_and_b32 v33, s79, v199
    v_fmac_f32_dpp v8, v18, v26 row_newbcast:12 row_mask:0xf bank_mask:0xf
    v_fmac_f32_dpp v9, v18, v27 row_newbcast:12 row_mask:0xf bank_mask:0xf
    v_fmac_f32_dpp v10, v18, v28 row_newbcast:12 row_mask:0xf bank_mask:0xf
    v_fmac_f32_dpp v11, v18, v29 row_newbcast:12 row_mask:0xf bank_mask:0xf
    v_fmac_f32_dpp v12, v18, v30 row_newbcast:12 row_mask:0xf bank_mask:0xf
    v_fmac_f32_dpp v13, v18, v31 row_newbcast:12 row_mask:0xf bank_mask:0xf
    v_fmac_f32_dpp v14, v18, v32 row_newbcast:12 row_mask:0xf bank_mask:0xf
    v_fmac_f32_dpp v15, v18, v33 row_newbcast:12 row_mask:0xf bank_mask:0xf
    buffer_load_dwordx4 v[184:187], v1, s[32:35], s94 offen offset:0 nt
    buffer_load_dwordx4 v[188:191], v1, s[32:35], s94 offen offset:1024 nt
    buffer_load_dwordx4 v[192:195], v1, s[32:35], s94 offen offset:2048 nt
    buffer_load_dwordx4 v[196:199], v1, s[32:35], s94 offen offset:3072 nt
    s_waitcnt vmcnt(45)
    v_dot2_f32_bf16 v18, v200, v4, 0
    v_dot2_f32_bf16 v19, v204, v4, 0
    v_dot2_f32_bf16 v20, v208, v4, 0
    v_dot2_f32_bf16 v21, v212, v4, 0
    v_dot2_f32_bf16 v18, v201, v5, v18
    v_dot2_f32_bf16 v19, v205, v5, v19
    v_dot2_f32_bf16 v20, v209, v5, v20
    v_dot2_f32_bf16 v21, v213, v5, v21
    v_dot2_f32_bf16 v18, v202, v6, v18
    v_dot2_f32_bf16 v19, v206, v6, v19
    v_dot2_f32_bf16 v20, v210, v6, v20
    v_dot2_f32_bf16 v21, v214, v6, v21
    v_dot2_f32_bf16 v18, v203, v7, v18
    v_dot2_f32_bf16 v19, v207, v7, v19
    v_dot2_f32_bf16 v20, v211, v7, v20
    v_dot2_f32_bf16 v21, v215, v7, v21
    s_add_u32 s95, s95, 32768
    s_add_u32 s98, s98, 1
    buffer_atomic_add v234, v36, s[44:47], 0 offen sc0 sc1
    buffer_load_dwordx4 v[200:203], v1, s[28:31], s95 offen offset:0 nt
    buffer_load_dwordx4 v[204:207], v1, s[28:31], s95 offen offset:1024 nt
    buffer_load_dwordx4 v[208:211], v1, s[28:31], s95 offen offset:2048 nt
    buffer_load_dwordx4 v[212:215], v1, s[28:31], s95 offen offset:3072 nt
    v_add_f32_dpp v18, v18, v18 row_mirror row_mask:0xf bank_mask:0x3
    v_add_f32_dpp v19, v19, v19 row_mirror row_mask:0xf bank_mask:0x3
    s_nop 0
    v_add_f32_dpp v18, v20, v20 row_mirror row_mask:0xf bank_mask:0xc
    v_add_f32_dpp v19, v21, v21 row_mirror row_mask:0xf bank_mask:0xc
    s_nop 0
    v_add_f32_dpp v18, v18, v18 row_half_mirror row_mask:0xf bank_mask:0x5
    s_nop 1
    v_add_f32_dpp v18, v19, v19 row_half_mirror row_mask:0xf bank_mask:0xa
    s_nop 1
    v_add_f32_dpp v18, v18, v18 quad_perm:[1,0,3,2] row_mask:0xf bank_mask:0xf
    s_nop 1
    v_add_f32_dpp v18, v18, v18 quad_perm:[2,3,0,1] row_mask:0xf bank_mask:0xf
    v_cvt_pk_bf16_f32 v18, v18, v18
    v_and_b32 v18, s79, v18
    v_mul_f32 v18, s78, v18
    v_cvt_pk_bf16_f32 v18, v18, v18
    v_and_b32 v18, s79, v18
    v_max_f32 v20, v18, v16
    s_nop 1
    v_max_f32_dpp v20, v20, v20 row_half_mirror row_mask:0xf bank_mask:0xf
    s_nop 1
    v_max_f32_dpp v20, v20, v20 row_mirror row_mask:0xf bank_mask:0xf
    v_mov_b32 v21, v20
    s_nop 1
    v_permlane32_swap_b32 v20, v21
    v_max_f32 v20, v20, v21
    v_mov_b32 v21, v20
    s_nop 1
    v_permlane16_swap_b32 v20, v21
    v_max_f32 v20, v20, v21
    v_sub_f32 v21, v16, v20
    v_sub_f32 v18, v18, v20
    v_mov_b32 v16, v20
    v_mul_f32 v21, s77, v21
    v_mul_f32 v18, s77, v18
    v_exp_f32 v21, v21
    v_exp_f32 v18, v18
    v_mul_f32 v8, v8, v21
    v_mul_f32 v9, v9, v21
    v_mul_f32 v10, v10, v21
    v_mul_f32 v11, v11, v21
    v_mul_f32 v12, v12, v21
    v_mul_f32 v13, v13, v21
    v_mul_f32 v14, v14, v21
    v_mul_f32 v15, v15, v21
    v_fma_f32 v17, v17, v21, v18
    s_waitcnt vmcnt(49)
    v_lshlrev_b32 v26, 16, v216
    v_and_b32 v27, s79, v216
    v_lshlrev_b32 v28, 16, v217
    v_and_b32 v29, s79, v217
    v_lshlrev_b32 v30, 16, v218
    v_and_b32 v31, s79, v218
    v_lshlrev_b32 v32, 16, v219
    v_and_b32 v33, s79, v219
    v_fmac_f32_dpp v8, v18, v26 row_newbcast:0 row_mask:0xf bank_mask:0xf
    v_fmac_f32_dpp v9, v18, v27 row_newbcast:0 row_mask:0xf bank_mask:0xf
    v_fmac_f32_dpp v10, v18, v28 row_newbcast:0 row_mask:0xf bank_mask:0xf
    v_fmac_f32_dpp v11, v18, v29 row_newbcast:0 row_mask:0xf bank_mask:0xf
    v_fmac_f32_dpp v12, v18, v30 row_newbcast:0 row_mask:0xf bank_mask:0xf
    v_fmac_f32_dpp v13, v18, v31 row_newbcast:0 row_mask:0xf bank_mask:0xf
    v_fmac_f32_dpp v14, v18, v32 row_newbcast:0 row_mask:0xf bank_mask:0xf
    v_fmac_f32_dpp v15, v18, v33 row_newbcast:0 row_mask:0xf bank_mask:0xf
    s_waitcnt vmcnt(48)
    v_lshlrev_b32 v26, 16, v220
    v_and_b32 v27, s79, v220
    v_lshlrev_b32 v28, 16, v221
    v_and_b32 v29, s79, v221
    v_lshlrev_b32 v30, 16, v222
    v_and_b32 v31, s79, v222
    v_lshlrev_b32 v32, 16, v223
    v_and_b32 v33, s79, v223
    v_fmac_f32_dpp v8, v18, v26 row_newbcast:4 row_mask:0xf bank_mask:0xf
    v_fmac_f32_dpp v9, v18, v27 row_newbcast:4 row_mask:0xf bank_mask:0xf
    v_fmac_f32_dpp v10, v18, v28 row_newbcast:4 row_mask:0xf bank_mask:0xf
    v_fmac_f32_dpp v11, v18, v29 row_newbcast:4 row_mask:0xf bank_mask:0xf
    v_fmac_f32_dpp v12, v18, v30 row_newbcast:4 row_mask:0xf bank_mask:0xf
    v_fmac_f32_dpp v13, v18, v31 row_newbcast:4 row_mask:0xf bank_mask:0xf
    v_fmac_f32_dpp v14, v18, v32 row_newbcast:4 row_mask:0xf bank_mask:0xf
    v_fmac_f32_dpp v15, v18, v33 row_newbcast:4 row_mask:0xf bank_mask:0xf
    s_waitcnt vmcnt(47)
    v_lshlrev_b32 v26, 16, v224
    v_and_b32 v27, s79, v224
    v_lshlrev_b32 v28, 16, v225
    v_and_b32 v29, s79, v225
    v_lshlrev_b32 v30, 16, v226
    v_and_b32 v31, s79, v226
    v_lshlrev_b32 v32, 16, v227
    v_and_b32 v33, s79, v227
    v_fmac_f32_dpp v8, v18, v26 row_newbcast:8 row_mask:0xf bank_mask:0xf
    v_fmac_f32_dpp v9, v18, v27 row_newbcast:8 row_mask:0xf bank_mask:0xf
    v_fmac_f32_dpp v10, v18, v28 row_newbcast:8 row_mask:0xf bank_mask:0xf
    v_fmac_f32_dpp v11, v18, v29 row_newbcast:8 row_mask:0xf bank_mask:0xf
    v_fmac_f32_dpp v12, v18, v30 row_newbcast:8 row_mask:0xf bank_mask:0xf
    v_fmac_f32_dpp v13, v18, v31 row_newbcast:8 row_mask:0xf bank_mask:0xf
    v_fmac_f32_dpp v14, v18, v32 row_newbcast:8 row_mask:0xf bank_mask:0xf
    v_fmac_f32_dpp v15, v18, v33 row_newbcast:8 row_mask:0xf bank_mask:0xf
    s_waitcnt vmcnt(46)
    v_lshlrev_b32 v26, 16, v228
    v_and_b32 v27, s79, v228
    v_lshlrev_b32 v28, 16, v229
    v_and_b32 v29, s79, v229
    v_lshlrev_b32 v30, 16, v230
    v_and_b32 v31, s79, v230
    v_lshlrev_b32 v32, 16, v231
    v_and_b32 v33, s79, v231
    v_fmac_f32_dpp v8, v18, v26 row_newbcast:12 row_mask:0xf bank_mask:0xf
    v_fmac_f32_dpp v9, v18, v27 row_newbcast:12 row_mask:0xf bank_mask:0xf
    v_fmac_f32_dpp v10, v18, v28 row_newbcast:12 row_mask:0xf bank_mask:0xf
    v_fmac_f32_dpp v11, v18, v29 row_newbcast:12 row_mask:0xf bank_mask:0xf
    v_fmac_f32_dpp v12, v18, v30 row_newbcast:12 row_mask:0xf bank_mask:0xf
    v_fmac_f32_dpp v13, v18, v31 row_newbcast:12 row_mask:0xf bank_mask:0xf
    v_fmac_f32_dpp v14, v18, v32 row_newbcast:12 row_mask:0xf bank_mask:0xf
    v_fmac_f32_dpp v15, v18, v33 row_newbcast:12 row_mask:0xf bank_mask:0xf
    buffer_load_dwordx4 v[216:219], v1, s[32:35], s95 offen offset:0 nt
    buffer_load_dwordx4 v[220:223], v1, s[32:35], s95 offen offset:1024 nt
    buffer_load_dwordx4 v[224:227], v1, s[32:35], s95 offen offset:2048 nt
    buffer_load_dwordx4 v[228:231], v1, s[32:35], s95 offen offset:3072 nt
    s_waitcnt vmcnt(46)
    v_dot2_f32_bf16 v18, v40, v4, 0
    v_dot2_f32_bf16 v19, v44, v4, 0
    v_dot2_f32_bf16 v20, v48, v4, 0
    v_dot2_f32_bf16 v21, v52, v4, 0
    v_dot2_f32_bf16 v18, v41, v5, v18
    v_dot2_f32_bf16 v19, v45, v5, v19
    v_dot2_f32_bf16 v20, v49, v5, v20
    v_dot2_f32_bf16 v21, v53, v5, v21
    v_dot2_f32_bf16 v18, v42, v6, v18
    v_dot2_f32_bf16 v19, v46, v6, v19
    v_dot2_f32_bf16 v20, v50, v6, v20
    v_dot2_f32_bf16 v21, v54, v6, v21
    v_dot2_f32_bf16 v18, v43, v7, v18
    v_dot2_f32_bf16 v19, v47, v7, v19
    v_dot2_f32_bf16 v20, v51, v7, v20
    v_dot2_f32_bf16 v21, v55, v7, v21
    v_add_f32_dpp v18, v18, v18 row_mirror row_mask:0xf bank_mask:0x3
    v_add_f32_dpp v19, v19, v19 row_mirror row_mask:0xf bank_mask:0x3
    s_nop 0
    v_add_f32_dpp v18, v20, v20 row_mirror row_mask:0xf bank_mask:0xc
    v_add_f32_dpp v19, v21, v21 row_mirror row_mask:0xf bank_mask:0xc
    s_nop 0
    v_add_f32_dpp v18, v18, v18 row_half_mirror row_mask:0xf bank_mask:0x5
    s_nop 1
    v_add_f32_dpp v18, v19, v19 row_half_mirror row_mask:0xf bank_mask:0xa
    s_nop 1
    v_add_f32_dpp v18, v18, v18 quad_perm:[1,0,3,2] row_mask:0xf bank_mask:0xf
    s_nop 1
    v_add_f32_dpp v18, v18, v18 quad_perm:[2,3,0,1] row_mask:0xf bank_mask:0xf
    v_cvt_pk_bf16_f32 v18, v18, v18
    v_and_b32 v18, s79, v18
    v_mul_f32 v18, s78, v18
    v_cvt_pk_bf16_f32 v18, v18, v18
    v_and_b32 v18, s79, v18
    v_max_f32 v20, v18, v16
    s_nop 1
    v_max_f32_dpp v20, v20, v20 row_half_mirror row_mask:0xf bank_mask:0xf
    s_nop 1
    v_max_f32_dpp v20, v20, v20 row_mirror row_mask:0xf bank_mask:0xf
    v_mov_b32 v21, v20
    s_nop 1
    v_permlane32_swap_b32 v20, v21
    v_max_f32 v20, v20, v21
    v_mov_b32 v21, v20
    s_nop 1
    v_permlane16_swap_b32 v20, v21
    v_max_f32 v20, v20, v21
    v_sub_f32 v21, v16, v20
    v_sub_f32 v18, v18, v20
    v_mov_b32 v16, v20
    v_mul_f32 v21, s77, v21
    v_mul_f32 v18, s77, v18
    v_exp_f32 v21, v21
    v_exp_f32 v18, v18
    v_mul_f32 v8, v8, v21
    v_mul_f32 v9, v9, v21
    v_mul_f32 v10, v10, v21
    v_mul_f32 v11, v11, v21
    v_mul_f32 v12, v12, v21
    v_mul_f32 v13, v13, v21
    v_mul_f32 v14, v14, v21
    v_mul_f32 v15, v15, v21
    v_fma_f32 v17, v17, v21, v18
    s_waitcnt vmcnt(45)
    v_lshlrev_b32 v26, 16, v56
    v_and_b32 v27, s79, v56
    v_lshlrev_b32 v28, 16, v57
    v_and_b32 v29, s79, v57
    v_lshlrev_b32 v30, 16, v58
    v_and_b32 v31, s79, v58
    v_lshlrev_b32 v32, 16, v59
    v_and_b32 v33, s79, v59
    v_fmac_f32_dpp v8, v18, v26 row_newbcast:0 row_mask:0xf bank_mask:0xf
    v_fmac_f32_dpp v9, v18, v27 row_newbcast:0 row_mask:0xf bank_mask:0xf
    v_fmac_f32_dpp v10, v18, v28 row_newbcast:0 row_mask:0xf bank_mask:0xf
    v_fmac_f32_dpp v11, v18, v29 row_newbcast:0 row_mask:0xf bank_mask:0xf
    v_fmac_f32_dpp v12, v18, v30 row_newbcast:0 row_mask:0xf bank_mask:0xf
    v_fmac_f32_dpp v13, v18, v31 row_newbcast:0 row_mask:0xf bank_mask:0xf
    v_fmac_f32_dpp v14, v18, v32 row_newbcast:0 row_mask:0xf bank_mask:0xf
    v_fmac_f32_dpp v15, v18, v33 row_newbcast:0 row_mask:0xf bank_mask:0xf
    s_waitcnt vmcnt(44)
    v_lshlrev_b32 v26, 16, v60
    v_and_b32 v27, s79, v60
    v_lshlrev_b32 v28, 16, v61
    v_and_b32 v29, s79, v61
    v_lshlrev_b32 v30, 16, v62
    v_and_b32 v31, s79, v62
    v_lshlrev_b32 v32, 16, v63
    v_and_b32 v33, s79, v63
    v_fmac_f32_dpp v8, v18, v26 row_newbcast:4 row_mask:0xf bank_mask:0xf
    v_fmac_f32_dpp v9, v18, v27 row_newbcast:4 row_mask:0xf bank_mask:0xf
    v_fmac_f32_dpp v10, v18, v28 row_newbcast:4 row_mask:0xf bank_mask:0xf
    v_fmac_f32_dpp v11, v18, v29 row_newbcast:4 row_mask:0xf bank_mask:0xf
    v_fmac_f32_dpp v12, v18, v30 row_newbcast:4 row_mask:0xf bank_mask:0xf
    v_fmac_f32_dpp v13, v18, v31 row_newbcast:4 row_mask:0xf bank_mask:0xf
    v_fmac_f32_dpp v14, v18, v32 row_newbcast:4 row_mask:0xf bank_mask:0xf
    v_fmac_f32_dpp v15, v18, v33 row_newbcast:4 row_mask:0xf bank_mask:0xf
    s_waitcnt vmcnt(43)
    v_lshlrev_b32 v26, 16, v64
    v_and_b32 v27, s79, v64
    v_lshlrev_b32 v28, 16, v65
    v_and_b32 v29, s79, v65
    v_lshlrev_b32 v30, 16, v66
    v_and_b32 v31, s79, v66
    v_lshlrev_b32 v32, 16, v67
    v_and_b32 v33, s79, v67
    v_fmac_f32_dpp v8, v18, v26 row_newbcast:8 row_mask:0xf bank_mask:0xf
    v_fmac_f32_dpp v9, v18, v27 row_newbcast:8 row_mask:0xf bank_mask:0xf
    v_fmac_f32_dpp v10, v18, v28 row_newbcast:8 row_mask:0xf bank_mask:0xf
    v_fmac_f32_dpp v11, v18, v29 row_newbcast:8 row_mask:0xf bank_mask:0xf
    v_fmac_f32_dpp v12, v18, v30 row_newbcast:8 row_mask:0xf bank_mask:0xf
    v_fmac_f32_dpp v13, v18, v31 row_newbcast:8 row_mask:0xf bank_mask:0xf
    v_fmac_f32_dpp v14, v18, v32 row_newbcast:8 row_mask:0xf bank_mask:0xf
    v_fmac_f32_dpp v15, v18, v33 row_newbcast:8 row_mask:0xf bank_mask:0xf
    s_waitcnt vmcnt(42)
    v_lshlrev_b32 v26, 16, v68
    v_and_b32 v27, s79, v68
    v_lshlrev_b32 v28, 16, v69
    v_and_b32 v29, s79, v69
    v_lshlrev_b32 v30, 16, v70
    v_and_b32 v31, s79, v70
    v_lshlrev_b32 v32, 16, v71
    v_and_b32 v33, s79, v71
    v_fmac_f32_dpp v8, v18, v26 row_newbcast:12 row_mask:0xf bank_mask:0xf
    v_fmac_f32_dpp v9, v18, v27 row_newbcast:12 row_mask:0xf bank_mask:0xf
    v_fmac_f32_dpp v10, v18, v28 row_newbcast:12 row_mask:0xf bank_mask:0xf
    v_fmac_f32_dpp v11, v18, v29 row_newbcast:12 row_mask:0xf bank_mask:0xf
    v_fmac_f32_dpp v12, v18, v30 row_newbcast:12 row_mask:0xf bank_mask:0xf
    v_fmac_f32_dpp v13, v18, v31 row_newbcast:12 row_mask:0xf bank_mask:0xf
    v_fmac_f32_dpp v14, v18, v32 row_newbcast:12 row_mask:0xf bank_mask:0xf
    v_fmac_f32_dpp v15, v18, v33 row_newbcast:12 row_mask:0xf bank_mask:0xf
    s_waitcnt vmcnt(38)
    v_dot2_f32_bf16 v18, v72, v4, 0
    v_dot2_f32_bf16 v19, v76, v4, 0
    v_dot2_f32_bf16 v20, v80, v4, 0
    v_dot2_f32_bf16 v21, v84, v4, 0
    v_dot2_f32_bf16 v18, v73, v5, v18
    v_dot2_f32_bf16 v19, v77, v5, v19
    v_dot2_f32_bf16 v20, v81, v5, v20
    v_dot2_f32_bf16 v21, v85, v5, v21
    v_dot2_f32_bf16 v18, v74, v6, v18
    v_dot2_f32_bf16 v19, v78, v6, v19
    v_dot2_f32_bf16 v20, v82, v6, v20
    v_dot2_f32_bf16 v21, v86, v6, v21
    v_dot2_f32_bf16 v18, v75, v7, v18
    v_dot2_f32_bf16 v19, v79, v7, v19
    v_dot2_f32_bf16 v20, v83, v7, v20
    v_dot2_f32_bf16 v21, v87, v7, v21
    v_add_f32_dpp v18, v18, v18 row_mirror row_mask:0xf bank_mask:0x3
    v_add_f32_dpp v19, v19, v19 row_mirror row_mask:0xf bank_mask:0x3
    s_nop 0
    v_add_f32_dpp v18, v20, v20 row_mirror row_mask:0xf bank_mask:0xc
    v_add_f32_dpp v19, v21, v21 row_mirror row_mask:0xf bank_mask:0xc
    s_nop 0
    v_add_f32_dpp v18, v18, v18 row_half_mirror row_mask:0xf bank_mask:0x5
    s_nop 1
    v_add_f32_dpp v18, v19, v19 row_half_mirror row_mask:0xf bank_mask:0xa
    s_nop 1
    v_add_f32_dpp v18, v18, v18 quad_perm:[1,0,3,2] row_mask:0xf bank_mask:0xf
    s_nop 1
    v_add_f32_dpp v18, v18, v18 quad_perm:[2,3,0,1] row_mask:0xf bank_mask:0xf
    v_cvt_pk_bf16_f32 v18, v18, v18
    v_and_b32 v18, s79, v18
    v_mul_f32 v18, s78, v18
    v_cvt_pk_bf16_f32 v18, v18, v18
    v_and_b32 v18, s79, v18
    v_max_f32 v20, v18, v16
    s_nop 1
    v_max_f32_dpp v20, v20, v20 row_half_mirror row_mask:0xf bank_mask:0xf
    s_nop 1
    v_max_f32_dpp v20, v20, v20 row_mirror row_mask:0xf bank_mask:0xf
    v_mov_b32 v21, v20
    s_nop 1
    v_permlane32_swap_b32 v20, v21
    v_max_f32 v20, v20, v21
    v_mov_b32 v21, v20
    s_nop 1
    v_permlane16_swap_b32 v20, v21
    v_max_f32 v20, v20, v21
    v_sub_f32 v21, v16, v20
    v_sub_f32 v18, v18, v20
    v_mov_b32 v16, v20
    v_mul_f32 v21, s77, v21
    v_mul_f32 v18, s77, v18
    v_exp_f32 v21, v21
    v_exp_f32 v18, v18
    v_mul_f32 v8, v8, v21
    v_mul_f32 v9, v9, v21
    v_mul_f32 v10, v10, v21
    v_mul_f32 v11, v11, v21
    v_mul_f32 v12, v12, v21
    v_mul_f32 v13, v13, v21
    v_mul_f32 v14, v14, v21
    v_mul_f32 v15, v15, v21
    v_fma_f32 v17, v17, v21, v18
    s_waitcnt vmcnt(37)
    v_lshlrev_b32 v26, 16, v88
    v_and_b32 v27, s79, v88
    v_lshlrev_b32 v28, 16, v89
    v_and_b32 v29, s79, v89
    v_lshlrev_b32 v30, 16, v90
    v_and_b32 v31, s79, v90
    v_lshlrev_b32 v32, 16, v91
    v_and_b32 v33, s79, v91
    v_fmac_f32_dpp v8, v18, v26 row_newbcast:0 row_mask:0xf bank_mask:0xf
    v_fmac_f32_dpp v9, v18, v27 row_newbcast:0 row_mask:0xf bank_mask:0xf
    v_fmac_f32_dpp v10, v18, v28 row_newbcast:0 row_mask:0xf bank_mask:0xf
    v_fmac_f32_dpp v11, v18, v29 row_newbcast:0 row_mask:0xf bank_mask:0xf
    v_fmac_f32_dpp v12, v18, v30 row_newbcast:0 row_mask:0xf bank_mask:0xf
    v_fmac_f32_dpp v13, v18, v31 row_newbcast:0 row_mask:0xf bank_mask:0xf
    v_fmac_f32_dpp v14, v18, v32 row_newbcast:0 row_mask:0xf bank_mask:0xf
    v_fmac_f32_dpp v15, v18, v33 row_newbcast:0 row_mask:0xf bank_mask:0xf
    s_waitcnt vmcnt(36)
    v_lshlrev_b32 v26, 16, v92
    v_and_b32 v27, s79, v92
    v_lshlrev_b32 v28, 16, v93
    v_and_b32 v29, s79, v93
    v_lshlrev_b32 v30, 16, v94
    v_and_b32 v31, s79, v94
    v_lshlrev_b32 v32, 16, v95
    v_and_b32 v33, s79, v95
    v_fmac_f32_dpp v8, v18, v26 row_newbcast:4 row_mask:0xf bank_mask:0xf
    v_fmac_f32_dpp v9, v18, v27 row_newbcast:4 row_mask:0xf bank_mask:0xf
    v_fmac_f32_dpp v10, v18, v28 row_newbcast:4 row_mask:0xf bank_mask:0xf
    v_fmac_f32_dpp v11, v18, v29 row_newbcast:4 row_mask:0xf bank_mask:0xf
    v_fmac_f32_dpp v12, v18, v30 row_newbcast:4 row_mask:0xf bank_mask:0xf
    v_fmac_f32_dpp v13, v18, v31 row_newbcast:4 row_mask:0xf bank_mask:0xf
    v_fmac_f32_dpp v14, v18, v32 row_newbcast:4 row_mask:0xf bank_mask:0xf
    v_fmac_f32_dpp v15, v18, v33 row_newbcast:4 row_mask:0xf bank_mask:0xf
    s_waitcnt vmcnt(35)
    v_lshlrev_b32 v26, 16, v96
    v_and_b32 v27, s79, v96
    v_lshlrev_b32 v28, 16, v97
    v_and_b32 v29, s79, v97
    v_lshlrev_b32 v30, 16, v98
    v_and_b32 v31, s79, v98
    v_lshlrev_b32 v32, 16, v99
    v_and_b32 v33, s79, v99
    v_fmac_f32_dpp v8, v18, v26 row_newbcast:8 row_mask:0xf bank_mask:0xf
    v_fmac_f32_dpp v9, v18, v27 row_newbcast:8 row_mask:0xf bank_mask:0xf
    v_fmac_f32_dpp v10, v18, v28 row_newbcast:8 row_mask:0xf bank_mask:0xf
    v_fmac_f32_dpp v11, v18, v29 row_newbcast:8 row_mask:0xf bank_mask:0xf
    v_fmac_f32_dpp v12, v18, v30 row_newbcast:8 row_mask:0xf bank_mask:0xf
    v_fmac_f32_dpp v13, v18, v31 row_newbcast:8 row_mask:0xf bank_mask:0xf
    v_fmac_f32_dpp v14, v18, v32 row_newbcast:8 row_mask:0xf bank_mask:0xf
    v_fmac_f32_dpp v15, v18, v33 row_newbcast:8 row_mask:0xf bank_mask:0xf
    s_waitcnt vmcnt(34)
    v_lshlrev_b32 v26, 16, v100
    v_and_b32 v27, s79, v100
    v_lshlrev_b32 v28, 16, v101
    v_and_b32 v29, s79, v101
    v_lshlrev_b32 v30, 16, v102
    v_and_b32 v31, s79, v102
    v_lshlrev_b32 v32, 16, v103
    v_and_b32 v33, s79, v103
    v_fmac_f32_dpp v8, v18, v26 row_newbcast:12 row_mask:0xf bank_mask:0xf
    v_fmac_f32_dpp v9, v18, v27 row_newbcast:12 row_mask:0xf bank_mask:0xf
    v_fmac_f32_dpp v10, v18, v28 row_newbcast:12 row_mask:0xf bank_mask:0xf
    v_fmac_f32_dpp v11, v18, v29 row_newbcast:12 row_mask:0xf bank_mask:0xf
    v_fmac_f32_dpp v12, v18, v30 row_newbcast:12 row_mask:0xf bank_mask:0xf
    v_fmac_f32_dpp v13, v18, v31 row_newbcast:12 row_mask:0xf bank_mask:0xf
    v_fmac_f32_dpp v14, v18, v32 row_newbcast:12 row_mask:0xf bank_mask:0xf
    v_fmac_f32_dpp v15, v18, v33 row_newbcast:12 row_mask:0xf bank_mask:0xf
    s_waitcnt vmcnt(30)
    v_dot2_f32_bf16 v18, v104, v4, 0
    v_dot2_f32_bf16 v19, v108, v4, 0
    v_dot2_f32_bf16 v20, v112, v4, 0
    v_dot2_f32_bf16 v21, v116, v4, 0
    v_dot2_f32_bf16 v18, v105, v5, v18
    v_dot2_f32_bf16 v19, v109, v5, v19
    v_dot2_f32_bf16 v20, v113, v5, v20
    v_dot2_f32_bf16 v21, v117, v5, v21
    v_dot2_f32_bf16 v18, v106, v6, v18
    v_dot2_f32_bf16 v19, v110, v6, v19
    v_dot2_f32_bf16 v20, v114, v6, v20
    v_dot2_f32_bf16 v21, v118, v6, v21
    v_dot2_f32_bf16 v18, v107, v7, v18
    v_dot2_f32_bf16 v19, v111, v7, v19
    v_dot2_f32_bf16 v20, v115, v7, v20
    v_dot2_f32_bf16 v21, v119, v7, v21
    v_add_f32_dpp v18, v18, v18 row_mirror row_mask:0xf bank_mask:0x3
    v_add_f32_dpp v19, v19, v19 row_mirror row_mask:0xf bank_mask:0x3
    s_nop 0
    v_add_f32_dpp v18, v20, v20 row_mirror row_mask:0xf bank_mask:0xc
    v_add_f32_dpp v19, v21, v21 row_mirror row_mask:0xf bank_mask:0xc
    s_nop 0
    v_add_f32_dpp v18, v18, v18 row_half_mirror row_mask:0xf bank_mask:0x5
    s_nop 1
    v_add_f32_dpp v18, v19, v19 row_half_mirror row_mask:0xf bank_mask:0xa
    s_nop 1
    v_add_f32_dpp v18, v18, v18 quad_perm:[1,0,3,2] row_mask:0xf bank_mask:0xf
    s_nop 1
    v_add_f32_dpp v18, v18, v18 quad_perm:[2,3,0,1] row_mask:0xf bank_mask:0xf
    v_cvt_pk_bf16_f32 v18, v18, v18
    v_and_b32 v18, s79, v18
    v_mul_f32 v18, s78, v18
    v_cvt_pk_bf16_f32 v18, v18, v18
    v_and_b32 v18, s79, v18
    v_max_f32 v20, v18, v16
    s_nop 1
    v_max_f32_dpp v20, v20, v20 row_half_mirror row_mask:0xf bank_mask:0xf
    s_nop 1
    v_max_f32_dpp v20, v20, v20 row_mirror row_mask:0xf bank_mask:0xf
    v_mov_b32 v21, v20
    s_nop 1
    v_permlane32_swap_b32 v20, v21
    v_max_f32 v20, v20, v21
    v_mov_b32 v21, v20
    s_nop 1
    v_permlane16_swap_b32 v20, v21
    v_max_f32 v20, v20, v21
    v_sub_f32 v21, v16, v20
    v_sub_f32 v18, v18, v20
    v_mov_b32 v16, v20
    v_mul_f32 v21, s77, v21
    v_mul_f32 v18, s77, v18
    v_exp_f32 v21, v21
    v_exp_f32 v18, v18
    v_mul_f32 v8, v8, v21
    v_mul_f32 v9, v9, v21
    v_mul_f32 v10, v10, v21
    v_mul_f32 v11, v11, v21
    v_mul_f32 v12, v12, v21
    v_mul_f32 v13, v13, v21
    v_mul_f32 v14, v14, v21
    v_mul_f32 v15, v15, v21
    v_fma_f32 v17, v17, v21, v18
    s_waitcnt vmcnt(29)
    v_lshlrev_b32 v26, 16, v120
    v_and_b32 v27, s79, v120
    v_lshlrev_b32 v28, 16, v121
    v_and_b32 v29, s79, v121
    v_lshlrev_b32 v30, 16, v122
    v_and_b32 v31, s79, v122
    v_lshlrev_b32 v32, 16, v123
    v_and_b32 v33, s79, v123
    v_fmac_f32_dpp v8, v18, v26 row_newbcast:0 row_mask:0xf bank_mask:0xf
    v_fmac_f32_dpp v9, v18, v27 row_newbcast:0 row_mask:0xf bank_mask:0xf
    v_fmac_f32_dpp v10, v18, v28 row_newbcast:0 row_mask:0xf bank_mask:0xf
    v_fmac_f32_dpp v11, v18, v29 row_newbcast:0 row_mask:0xf bank_mask:0xf
    v_fmac_f32_dpp v12, v18, v30 row_newbcast:0 row_mask:0xf bank_mask:0xf
    v_fmac_f32_dpp v13, v18, v31 row_newbcast:0 row_mask:0xf bank_mask:0xf
    v_fmac_f32_dpp v14, v18, v32 row_newbcast:0 row_mask:0xf bank_mask:0xf
    v_fmac_f32_dpp v15, v18, v33 row_newbcast:0 row_mask:0xf bank_mask:0xf
    s_waitcnt vmcnt(28)
    v_lshlrev_b32 v26, 16, v124
    v_and_b32 v27, s79, v124
    v_lshlrev_b32 v28, 16, v125
    v_and_b32 v29, s79, v125
    v_lshlrev_b32 v30, 16, v126
    v_and_b32 v31, s79, v126
    v_lshlrev_b32 v32, 16, v127
    v_and_b32 v33, s79, v127
    v_fmac_f32_dpp v8, v18, v26 row_newbcast:4 row_mask:0xf bank_mask:0xf
    v_fmac_f32_dpp v9, v18, v27 row_newbcast:4 row_mask:0xf bank_mask:0xf
    v_fmac_f32_dpp v10, v18, v28 row_newbcast:4 row_mask:0xf bank_mask:0xf
    v_fmac_f32_dpp v11, v18, v29 row_newbcast:4 row_mask:0xf bank_mask:0xf
    v_fmac_f32_dpp v12, v18, v30 row_newbcast:4 row_mask:0xf bank_mask:0xf
    v_fmac_f32_dpp v13, v18, v31 row_newbcast:4 row_mask:0xf bank_mask:0xf
    v_fmac_f32_dpp v14, v18, v32 row_newbcast:4 row_mask:0xf bank_mask:0xf
    v_fmac_f32_dpp v15, v18, v33 row_newbcast:4 row_mask:0xf bank_mask:0xf
    s_waitcnt vmcnt(27)
    v_lshlrev_b32 v26, 16, v128
    v_and_b32 v27, s79, v128
    v_lshlrev_b32 v28, 16, v129
    v_and_b32 v29, s79, v129
    v_lshlrev_b32 v30, 16, v130
    v_and_b32 v31, s79, v130
    v_lshlrev_b32 v32, 16, v131
    v_and_b32 v33, s79, v131
    v_fmac_f32_dpp v8, v18, v26 row_newbcast:8 row_mask:0xf bank_mask:0xf
    v_fmac_f32_dpp v9, v18, v27 row_newbcast:8 row_mask:0xf bank_mask:0xf
    v_fmac_f32_dpp v10, v18, v28 row_newbcast:8 row_mask:0xf bank_mask:0xf
    v_fmac_f32_dpp v11, v18, v29 row_newbcast:8 row_mask:0xf bank_mask:0xf
    v_fmac_f32_dpp v12, v18, v30 row_newbcast:8 row_mask:0xf bank_mask:0xf
    v_fmac_f32_dpp v13, v18, v31 row_newbcast:8 row_mask:0xf bank_mask:0xf
    v_fmac_f32_dpp v14, v18, v32 row_newbcast:8 row_mask:0xf bank_mask:0xf
    v_fmac_f32_dpp v15, v18, v33 row_newbcast:8 row_mask:0xf bank_mask:0xf
    s_waitcnt vmcnt(26)
    v_lshlrev_b32 v26, 16, v132
    v_and_b32 v27, s79, v132
    v_lshlrev_b32 v28, 16, v133
    v_and_b32 v29, s79, v133
    v_lshlrev_b32 v30, 16, v134
    v_and_b32 v31, s79, v134
    v_lshlrev_b32 v32, 16, v135
    v_and_b32 v33, s79, v135
    v_fmac_f32_dpp v8, v18, v26 row_newbcast:12 row_mask:0xf bank_mask:0xf
    v_fmac_f32_dpp v9, v18, v27 row_newbcast:12 row_mask:0xf bank_mask:0xf
    v_fmac_f32_dpp v10, v18, v28 row_newbcast:12 row_mask:0xf bank_mask:0xf
    v_fmac_f32_dpp v11, v18, v29 row_newbcast:12 row_mask:0xf bank_mask:0xf
    v_fmac_f32_dpp v12, v18, v30 row_newbcast:12 row_mask:0xf bank_mask:0xf
    v_fmac_f32_dpp v13, v18, v31 row_newbcast:12 row_mask:0xf bank_mask:0xf
    v_fmac_f32_dpp v14, v18, v32 row_newbcast:12 row_mask:0xf bank_mask:0xf
    v_fmac_f32_dpp v15, v18, v33 row_newbcast:12 row_mask:0xf bank_mask:0xf
    s_waitcnt vmcnt(22)
    v_dot2_f32_bf16 v18, v136, v4, 0
    v_dot2_f32_bf16 v19, v140, v4, 0
    v_dot2_f32_bf16 v20, v144, v4, 0
    v_dot2_f32_bf16 v21, v148, v4, 0
    v_dot2_f32_bf16 v18, v137, v5, v18
    v_dot2_f32_bf16 v19, v141, v5, v19
    v_dot2_f32_bf16 v20, v145, v5, v20
    v_dot2_f32_bf16 v21, v149, v5, v21
    v_dot2_f32_bf16 v18, v138, v6, v18
    v_dot2_f32_bf16 v19, v142, v6, v19
    v_dot2_f32_bf16 v20, v146, v6, v20
    v_dot2_f32_bf16 v21, v150, v6, v21
    v_dot2_f32_bf16 v18, v139, v7, v18
    v_dot2_f32_bf16 v19, v143, v7, v19
    v_dot2_f32_bf16 v20, v147, v7, v20
    v_dot2_f32_bf16 v21, v151, v7, v21
    v_add_f32_dpp v18, v18, v18 row_mirror row_mask:0xf bank_mask:0x3
    v_add_f32_dpp v19, v19, v19 row_mirror row_mask:0xf bank_mask:0x3
    s_nop 0
    v_add_f32_dpp v18, v20, v20 row_mirror row_mask:0xf bank_mask:0xc
    v_add_f32_dpp v19, v21, v21 row_mirror row_mask:0xf bank_mask:0xc
    s_nop 0
    v_add_f32_dpp v18, v18, v18 row_half_mirror row_mask:0xf bank_mask:0x5
    s_nop 1
    v_add_f32_dpp v18, v19, v19 row_half_mirror row_mask:0xf bank_mask:0xa
    s_nop 1
    v_add_f32_dpp v18, v18, v18 quad_perm:[1,0,3,2] row_mask:0xf bank_mask:0xf
    s_nop 1
    v_add_f32_dpp v18, v18, v18 quad_perm:[2,3,0,1] row_mask:0xf bank_mask:0xf
    v_cvt_pk_bf16_f32 v18, v18, v18
    v_and_b32 v18, s79, v18
    v_mul_f32 v18, s78, v18
    v_cvt_pk_bf16_f32 v18, v18, v18
    v_and_b32 v18, s79, v18
    v_max_f32 v20, v18, v16
    s_nop 1
    v_max_f32_dpp v20, v20, v20 row_half_mirror row_mask:0xf bank_mask:0xf
    s_nop 1
    v_max_f32_dpp v20, v20, v20 row_mirror row_mask:0xf bank_mask:0xf
    v_mov_b32 v21, v20
    s_nop 1
    v_permlane32_swap_b32 v20, v21
    v_max_f32 v20, v20, v21
    v_mov_b32 v21, v20
    s_nop 1
    v_permlane16_swap_b32 v20, v21
    v_max_f32 v20, v20, v21
    v_sub_f32 v21, v16, v20
    v_sub_f32 v18, v18, v20
    v_mov_b32 v16, v20
    v_mul_f32 v21, s77, v21
    v_mul_f32 v18, s77, v18
    v_exp_f32 v21, v21
    v_exp_f32 v18, v18
    v_mul_f32 v8, v8, v21
    v_mul_f32 v9, v9, v21
    v_mul_f32 v10, v10, v21
    v_mul_f32 v11, v11, v21
    v_mul_f32 v12, v12, v21
    v_mul_f32 v13, v13, v21
    v_mul_f32 v14, v14, v21
    v_mul_f32 v15, v15, v21
    v_fma_f32 v17, v17, v21, v18
    s_waitcnt vmcnt(21)
    v_lshlrev_b32 v26, 16, v152
    v_and_b32 v27, s79, v152
    v_lshlrev_b32 v28, 16, v153
    v_and_b32 v29, s79, v153
    v_lshlrev_b32 v30, 16, v154
    v_and_b32 v31, s79, v154
    v_lshlrev_b32 v32, 16, v155
    v_and_b32 v33, s79, v155
    v_fmac_f32_dpp v8, v18, v26 row_newbcast:0 row_mask:0xf bank_mask:0xf
    v_fmac_f32_dpp v9, v18, v27 row_newbcast:0 row_mask:0xf bank_mask:0xf
    v_fmac_f32_dpp v10, v18, v28 row_newbcast:0 row_mask:0xf bank_mask:0xf
    v_fmac_f32_dpp v11, v18, v29 row_newbcast:0 row_mask:0xf bank_mask:0xf
    v_fmac_f32_dpp v12, v18, v30 row_newbcast:0 row_mask:0xf bank_mask:0xf
    v_fmac_f32_dpp v13, v18, v31 row_newbcast:0 row_mask:0xf bank_mask:0xf
    v_fmac_f32_dpp v14, v18, v32 row_newbcast:0 row_mask:0xf bank_mask:0xf
    v_fmac_f32_dpp v15, v18, v33 row_newbcast:0 row_mask:0xf bank_mask:0xf
    s_waitcnt vmcnt(20)
    v_lshlrev_b32 v26, 16, v156
    v_and_b32 v27, s79, v156
    v_lshlrev_b32 v28, 16, v157
    v_and_b32 v29, s79, v157
    v_lshlrev_b32 v30, 16, v158
    v_and_b32 v31, s79, v158
    v_lshlrev_b32 v32, 16, v159
    v_and_b32 v33, s79, v159
    v_fmac_f32_dpp v8, v18, v26 row_newbcast:4 row_mask:0xf bank_mask:0xf
    v_fmac_f32_dpp v9, v18, v27 row_newbcast:4 row_mask:0xf bank_mask:0xf
    v_fmac_f32_dpp v10, v18, v28 row_newbcast:4 row_mask:0xf bank_mask:0xf
    v_fmac_f32_dpp v11, v18, v29 row_newbcast:4 row_mask:0xf bank_mask:0xf
    v_fmac_f32_dpp v12, v18, v30 row_newbcast:4 row_mask:0xf bank_mask:0xf
    v_fmac_f32_dpp v13, v18, v31 row_newbcast:4 row_mask:0xf bank_mask:0xf
    v_fmac_f32_dpp v14, v18, v32 row_newbcast:4 row_mask:0xf bank_mask:0xf
    v_fmac_f32_dpp v15, v18, v33 row_newbcast:4 row_mask:0xf bank_mask:0xf
    s_waitcnt vmcnt(19)
    v_lshlrev_b32 v26, 16, v160
    v_and_b32 v27, s79, v160
    v_lshlrev_b32 v28, 16, v161
    v_and_b32 v29, s79, v161
    v_lshlrev_b32 v30, 16, v162
    v_and_b32 v31, s79, v162
    v_lshlrev_b32 v32, 16, v163
    v_and_b32 v33, s79, v163
    v_fmac_f32_dpp v8, v18, v26 row_newbcast:8 row_mask:0xf bank_mask:0xf
    v_fmac_f32_dpp v9, v18, v27 row_newbcast:8 row_mask:0xf bank_mask:0xf
    v_fmac_f32_dpp v10, v18, v28 row_newbcast:8 row_mask:0xf bank_mask:0xf
    v_fmac_f32_dpp v11, v18, v29 row_newbcast:8 row_mask:0xf bank_mask:0xf
    v_fmac_f32_dpp v12, v18, v30 row_newbcast:8 row_mask:0xf bank_mask:0xf
    v_fmac_f32_dpp v13, v18, v31 row_newbcast:8 row_mask:0xf bank_mask:0xf
    v_fmac_f32_dpp v14, v18, v32 row_newbcast:8 row_mask:0xf bank_mask:0xf
    v_fmac_f32_dpp v15, v18, v33 row_newbcast:8 row_mask:0xf bank_mask:0xf
    s_waitcnt vmcnt(18)
    v_lshlrev_b32 v26, 16, v164
    v_and_b32 v27, s79, v164
    v_lshlrev_b32 v28, 16, v165
    v_and_b32 v29, s79, v165
    v_lshlrev_b32 v30, 16, v166
    v_and_b32 v31, s79, v166
    v_lshlrev_b32 v32, 16, v167
    v_and_b32 v33, s79, v167
    v_fmac_f32_dpp v8, v18, v26 row_newbcast:12 row_mask:0xf bank_mask:0xf
    v_fmac_f32_dpp v9, v18, v27 row_newbcast:12 row_mask:0xf bank_mask:0xf
    v_fmac_f32_dpp v10, v18, v28 row_newbcast:12 row_mask:0xf bank_mask:0xf
    v_fmac_f32_dpp v11, v18, v29 row_newbcast:12 row_mask:0xf bank_mask:0xf
    v_fmac_f32_dpp v12, v18, v30 row_newbcast:12 row_mask:0xf bank_mask:0xf
    v_fmac_f32_dpp v13, v18, v31 row_newbcast:12 row_mask:0xf bank_mask:0xf
    v_fmac_f32_dpp v14, v18, v32 row_newbcast:12 row_mask:0xf bank_mask:0xf
    v_fmac_f32_dpp v15, v18, v33 row_newbcast:12 row_mask:0xf bank_mask:0xf
    s_nop 1
L_loop:
    s_cmp_ge_u32 s94, 4194304
    s_cbranch_scc1 L_done
    s_cmp_lt_u32 s98, 22
    s_cbranch_scc1 L_ntm
    ds_write_b32 v37, v36 offset:2592
L_ntm:
    s_cmp_lg_u32 s98, 24
    s_cbranch_scc1 L_ng4
    s_mov_b32 s76, 0
L_g4:
    ds_read_b32 v26, v37 offset:2576
    s_waitcnt lgkmcnt(0)
    v_readfirstlane_b32 s82, v26
    s_cmp_lg_u32 s82, 0
    s_nop 3
    s_cbranch_scc1 L_gok4
    s_add_u32 s76, s76, 1
    s_cmp_lt_u32 s76, 480000
    s_cbranch_scc1 L_g4
L_gok4:
    s_mov_b32 s74, s99
    s_nop 0
L_ng4:
    s_waitcnt vmcnt(13)
    v_readfirstlane_b32 s82, v233
    v_dot2_f32_bf16 v18, v168, v4, 0
    v_dot2_f32_bf16 v19, v172, v4, 0
    v_dot2_f32_bf16 v20, v176, v4, 0
    v_dot2_f32_bf16 v21, v180, v4, 0
    v_dot2_f32_bf16 v18, v169, v5, v18
    v_dot2_f32_bf16 v19, v173, v5, v19
    v_dot2_f32_bf16 v20, v177, v5, v20
    v_dot2_f32_bf16 v21, v181, v5, v21
    v_dot2_f32_bf16 v18, v170, v6, v18
    v_dot2_f32_bf16 v19, v174, v6, v19
    v_dot2_f32_bf16 v20, v178, v6, v20
    v_dot2_f32_bf16 v21, v182, v6, v21
    v_dot2_f32_bf16 v18, v171, v7, v18
    v_dot2_f32_bf16 v19, v175, v7, v19
    v_dot2_f32_bf16 v20, v179, v7, v20
    v_dot2_f32_bf16 v21, v183, v7, v21
    v_mov_b32 v233, 1
    s_add_u32 s82, s82, 833
    s_min_u32 s82, s82, 1024
    s_lshl_b32 s82, s82, 12
    s_add_u32 s83, s94, 32768
    s_cmp_lt_u32 s98, 26
    s_cselect_b32 s94, s83, s82
    s_add_u32 s98, s98, 1
    buffer_atomic_add v233, v232, s[44:47], s74 offen sc0 sc1
    buffer_load_dwordx4 v[168:171], v1, s[28:31], s94 offen offset:0 nt
    buffer_load_dwordx4 v[172:175], v1, s[28:31], s94 offen offset:1024 nt
    buffer_load_dwordx4 v[176:179], v1, s[28:31], s94 offen offset:2048 nt
    buffer_load_dwordx4 v[180:183], v1, s[28:31], s94 offen offset:3072 nt
    v_add_f32_dpp v18, v18, v18 row_mirror row_mask:0xf bank_mask:0x3
    v_add_f32_dpp v19, v19, v19 row_mirror row_mask:0xf bank_mask:0x3
    s_nop 0
    v_add_f32_dpp v18, v20, v20 row_mirror row_mask:0xf bank_mask:0xc
    v_add_f32_dpp v19, v21, v21 row_mirror row_mask:0xf bank_mask:0xc
    s_nop 0
    v_add_f32_dpp v18, v18, v18 row_half_mirror row_mask:0xf bank_mask:0x5
    s_nop 1
    v_add_f32_dpp v18, v19, v19 row_half_mirror row_mask:0xf bank_mask:0xa
    s_nop 1
    v_add_f32_dpp v18, v18, v18 quad_perm:[1,0,3,2] row_mask:0xf bank_mask:0xf
    s_nop 1
    v_add_f32_dpp v18, v18, v18 quad_perm:[2,3,0,1] row_mask:0xf bank_mask:0xf
    v_cvt_pk_bf16_f32 v18, v18, v18
    v_and_b32 v18, s79, v18
    v_mul_f32 v18, s78, v18
    v_cvt_pk_bf16_f32 v18, v18, v18
    v_and_b32 v18, s79, v18
    v_max_f32 v20, v18, v16
    s_nop 1
    v_max_f32_dpp v20, v20, v20 row_half_mirror row_mask:0xf bank_mask:0xf
    s_nop 1
    v_max_f32_dpp v20, v20, v20 row_mirror row_mask:0xf bank_mask:0xf
    v_mov_b32 v21, v20
    s_nop 1
    v_permlane32_swap_b32 v20, v21
    v_max_f32 v20, v20, v21
    v_mov_b32 v21, v20
    s_nop 1
    v_permlane16_swap_b32 v20, v21
    v_max_f32 v20, v20, v21
    v_sub_f32 v21, v16, v20
    v_sub_f32 v18, v18, v20
    v_mov_b32 v16, v20
    v_mul_f32 v21, s77, v21
    v_mul_f32 v18, s77, v18
    v_exp_f32 v21, v21
    v_exp_f32 v18, v18
    v_mul_f32 v8, v8, v21
    v_mul_f32 v9, v9, v21
    v_mul_f32 v10, v10, v21
    v_mul_f32 v11, v11, v21
    v_mul_f32 v12, v12, v21
    v_mul_f32 v13, v13, v21
    v_mul_f32 v14, v14, v21
    v_mul_f32 v15, v15, v21
    v_fma_f32 v17, v17, v21, v18
    s_waitcnt vmcnt(17)
    v_lshlrev_b32 v26, 16, v184
    v_and_b32 v27, s79, v184
    v_lshlrev_b32 v28, 16, v185
    v_and_b32 v29, s79, v185
    v_lshlrev_b32 v30, 16, v186
    v_and_b32 v31, s79, v186
    v_lshlrev_b32 v32, 16, v187
    v_and_b32 v33, s79, v187
    v_fmac_f32_dpp v8, v18, v26 row_newbcast:0 row_mask:0xf bank_mask:0xf
    v_fmac_f32_dpp v9, v18, v27 row_newbcast:0 row_mask:0xf bank_mask:0xf
    v_fmac_f32_dpp v10, v18, v28 row_newbcast:0 row_mask:0xf bank_mask:0xf
    v_fmac_f32_dpp v11, v18, v29 row_newbcast:0 row_mask:0xf bank_mask:0xf
    v_fmac_f32_dpp v12, v18, v30 row_newbcast:0 row_mask:0xf bank_mask:0xf
    v_fmac_f32_dpp v13, v18, v31 row_newbcast:0 row_mask:0xf bank_mask:0xf
    v_fmac_f32_dpp v14, v18, v32 row_newbcast:0 row_mask:0xf bank_mask:0xf
    v_fmac_f32_dpp v15, v18, v33 row_newbcast:0 row_mask:0xf bank_mask:0xf
    s_waitcnt vmcnt(16)
    v_lshlrev_b32 v26, 16, v188
    v_and_b32_e64 v27, s79, v188
    v_lshlrev_b32 v28, 16, v189
    v_and_b32 v29, s79, v189
    v_lshlrev_b32 v30, 16, v190
    v_and_b32 v31, s79, v190
    v_lshlrev_b32 v32, 16, v191
    v_and_b32 v33, s79, v191
    v_fmac_f32_dpp v8, v18, v26 row_newbcast:4 row_mask:0xf bank_mask:0xf
    v_fmac_f32_dpp v9, v18, v27 row_newbcast:4 row_mask:0xf bank_mask:0xf
    v_fmac_f32_dpp v10, v18, v28 row_newbcast:4 row_mask:0xf bank_mask:0xf
    v_fmac_f32_dpp v11, v18, v29 row_newbcast:4 row_mask:0xf bank_mask:0xf
    v_fmac_f32_dpp v12, v18, v30 row_newbcast:4 row_mask:0xf bank_mask:0xf
    v_fmac_f32_dpp v13, v18, v31 row_newbcast:4 row_mask:0xf bank_mask:0xf
    v_fmac_f32_dpp v14, v18, v32 row_newbcast:4 row_mask:0xf bank_mask:0xf
    v_fmac_f32_dpp v15, v18, v33 row_newbcast:4 row_mask:0xf bank_mask:0xf
    s_waitcnt vmcnt(15)
    v_lshlrev_b32 v26, 16, v192
    v_and_b32_e64 v27, s79, v192
    v_lshlrev_b32 v28, 16, v193
    v_and_b32 v29, s79, v193
    v_lshlrev_b32 v30, 16, v194
    v_and_b32 v31, s79, v194
    v_lshlrev_b32 v32, 16, v195
    v_and_b32 v33, s79, v195
    v_fmac_f32_dpp v8, v18, v26 row_newbcast:8 row_mask:0xf bank_mask:0xf
    v_fmac_f32_dpp v9, v18, v27 row_newbcast:8 row_mask:0xf bank_mask:0xf
    v_fmac_f32_dpp v10, v18, v28 row_newbcast:8 row_mask:0xf bank_mask:0xf
    v_fmac_f32_dpp v11, v18, v29 row_newbcast:8 row_mask:0xf bank_mask:0xf
    v_fmac_f32_dpp v12, v18, v30 row_newbcast:8 row_mask:0xf bank_mask:0xf
    v_fmac_f32_dpp v13, v18, v31 row_newbcast:8 row_mask:0xf bank_mask:0xf
    v_fmac_f32_dpp v14, v18, v32 row_newbcast:8 row_mask:0xf bank_mask:0xf
    v_fmac_f32_dpp v15, v18, v33 row_newbcast:8 row_mask:0xf bank_mask:0xf
    s_waitcnt vmcnt(14)
    v_lshlrev_b32 v26, 16, v196
    v_and_b32_e64 v27, s79, v196
    v_lshlrev_b32 v28, 16, v197
    v_and_b32 v29, s79, v197
    v_lshlrev_b32 v30, 16, v198
    v_and_b32 v31, s79, v198
    v_lshlrev_b32 v32, 16, v199
    v_and_b32 v33, s79, v199
    v_fmac_f32_dpp v8, v18, v26 row_newbcast:12 row_mask:0xf bank_mask:0xf
    v_fmac_f32_dpp v9, v18, v27 row_newbcast:12 row_mask:0xf bank_mask:0xf
    v_fmac_f32_dpp v10, v18, v28 row_newbcast:12 row_mask:0xf bank_mask:0xf
    v_fmac_f32_dpp v11, v18, v29 row_newbcast:12 row_mask:0xf bank_mask:0xf
    v_fmac_f32_dpp v12, v18, v30 row_newbcast:12 row_mask:0xf bank_mask:0xf
    v_fmac_f32_dpp v13, v18, v31 row_newbcast:12 row_mask:0xf bank_mask:0xf
    v_fmac_f32_dpp v14, v18, v32 row_newbcast:12 row_mask:0xf bank_mask:0xf
    v_fmac_f32_dpp v15, v18, v33 row_newbcast:12 row_mask:0xf bank_mask:0xf
    buffer_load_dwordx4 v[184:187], v1, s[32:35], s94 offen offset:0 nt
    buffer_load_dwordx4 v[188:191], v1, s[32:35], s94 offen offset:1024 nt
    buffer_load_dwordx4 v[192:195], v1, s[32:35], s94 offen offset:2048 nt
    buffer_load_dwordx4 v[196:199], v1, s[32:35], s94 offen offset:3072 nt
    s_cmp_ge_u32 s95, 4194304
    s_cbranch_scc1 L_done
    s_cmp_lg_u32 s98, 24
    s_cbranch_scc1 L_ng5
    s_mov_b32 s76, 0
L_g5:
    ds_read_b32 v26, v37 offset:2576
    s_waitcnt lgkmcnt(0)
    v_readfirstlane_b32 s82, v26
    s_cmp_lg_u32 s82, 0
    s_nop 3
    s_cbranch_scc1 L_gok5
    s_add_u32 s76, s76, 1
    s_cmp_lt_u32 s76, 480000
    s_cbranch_scc1 L_g5
L_gok5:
    s_mov_b32 s74, s99
L_ng5:
    s_waitcnt vmcnt(13)
    v_readfirstlane_b32 s82, v234
    v_dot2_f32_bf16 v18, v200, v4, 0
    v_dot2_f32_bf16 v19, v204, v4, 0
    v_dot2_f32_bf16 v20, v208, v4, 0
    v_dot2_f32_bf16 v21, v212, v4, 0
    v_dot2_f32_bf16 v18, v201, v5, v18
    v_dot2_f32_bf16 v19, v205, v5, v19
    v_dot2_f32_bf16 v20, v209, v5, v20
    v_dot2_f32_bf16 v21, v213, v5, v21
    v_dot2_f32_bf16 v18, v202, v6, v18
    v_dot2_f32_bf16 v19, v206, v6, v19
    v_dot2_f32_bf16 v20, v210, v6, v20
    v_dot2_f32_bf16 v21, v214, v6, v21
    v_dot2_f32_bf16 v18, v203, v7, v18
    v_dot2_f32_bf16 v19, v207, v7, v19
    v_dot2_f32_bf16 v20, v211, v7, v20
    v_dot2_f32_bf16 v21, v215, v7, v21
    v_mov_b32 v234, 1
    s_add_u32 s82, s82, 833
    s_min_u32 s82, s82, 1024
    s_lshl_b32 s82, s82, 12
    s_add_u32 s83, s95, 32768
    s_cmp_lt_u32 s98, 26
    s_cselect_b32 s95, s83, s82
    s_add_u32 s98, s98, 1
    buffer_atomic_add v234, v232, s[44:47], s74 offen sc0 sc1
    buffer_load_dwordx4 v[200:203], v1, s[28:31], s95 offen offset:0 nt
    buffer_load_dwordx4 v[204:207], v1, s[28:31], s95 offen offset:1024 nt
    buffer_load_dwordx4 v[208:211], v1, s[28:31], s95 offen offset:2048 nt
    buffer_load_dwordx4 v[212:215], v1, s[28:31], s95 offen offset:3072 nt
    v_add_f32_dpp v18, v18, v18 row_mirror row_mask:0xf bank_mask:0x3
    v_add_f32_dpp v19, v19, v19 row_mirror row_mask:0xf bank_mask:0x3
    s_nop 0
    v_add_f32_dpp v18, v20, v20 row_mirror row_mask:0xf bank_mask:0xc
    v_add_f32_dpp v19, v21, v21 row_mirror row_mask:0xf bank_mask:0xc
    s_nop 0
    v_add_f32_dpp v18, v18, v18 row_half_mirror row_mask:0xf bank_mask:0x5
    s_nop 1
    v_add_f32_dpp v18, v19, v19 row_half_mirror row_mask:0xf bank_mask:0xa
    s_nop 1
    v_add_f32_dpp v18, v18, v18 quad_perm:[1,0,3,2] row_mask:0xf bank_mask:0xf
    s_nop 1
    v_add_f32_dpp v18, v18, v18 quad_perm:[2,3,0,1] row_mask:0xf bank_mask:0xf
    v_cvt_pk_bf16_f32 v18, v18, v18
    v_and_b32 v18, s79, v18
    v_mul_f32 v18, s78, v18
    v_cvt_pk_bf16_f32 v18, v18, v18
    v_and_b32 v18, s79, v18
    v_max_f32 v20, v18, v16
    s_nop 1
    v_max_f32_dpp v20, v20, v20 row_half_mirror row_mask:0xf bank_mask:0xf
    s_nop 1
    v_max_f32_dpp v20, v20, v20 row_mirror row_mask:0xf bank_mask:0xf
    v_mov_b32 v21, v20
    s_nop 1
    v_permlane32_swap_b32 v20, v21
    v_max_f32 v20, v20, v21
    v_mov_b32 v21, v20
    s_nop 1
    v_permlane16_swap_b32 v20, v21
    v_max_f32 v20, v20, v21
    v_sub_f32 v21, v16, v20
    v_sub_f32 v18, v18, v20
    v_mov_b32 v16, v20
    v_mul_f32 v21, s77, v21
    v_mul_f32 v18, s77, v18
    v_exp_f32 v21, v21
    v_exp_f32 v18, v18
    v_mul_f32 v8, v8, v21
    v_mul_f32 v9, v9, v21
    v_mul_f32 v10, v10, v21
    v_mul_f32 v11, v11, v21
    v_mul_f32 v12, v12, v21
    v_mul_f32 v13, v13, v21
    v_mul_f32 v14, v14, v21
    v_mul_f32 v15, v15, v21
    v_fma_f32 v17, v17, v21, v18
    s_waitcnt vmcnt(17)
    v_lshlrev_b32 v26, 16, v216
    v_and_b32 v27, s79, v216
    v_lshlrev_b32 v28, 16, v217
    v_and_b32 v29, s79, v217
    v_lshlrev_b32 v30, 16, v218
    v_and_b32 v31, s79, v218
    v_lshlrev_b32 v32, 16, v219
    v_and_b32 v33, s79, v219
    v_fmac_f32_dpp v8, v18, v26 row_newbcast:0 row_mask:0xf bank_mask:0xf
    v_fmac_f32_dpp v9, v18, v27 row_newbcast:0 row_mask:0xf bank_mask:0xf
    v_fmac_f32_dpp v10, v18, v28 row_newbcast:0 row_mask:0xf bank_mask:0xf
    v_fmac_f32_dpp v11, v18, v29 row_newbcast:0 row_mask:0xf bank_mask:0xf
    v_fmac_f32_dpp v12, v18, v30 row_newbcast:0 row_mask:0xf bank_mask:0xf
    v_fmac_f32_dpp v13, v18, v31 row_newbcast:0 row_mask:0xf bank_mask:0xf
    v_fmac_f32_dpp v14, v18, v32 row_newbcast:0 row_mask:0xf bank_mask:0xf
    v_fmac_f32_dpp v15, v18, v33 row_newbcast:0 row_mask:0xf bank_mask:0xf
    s_waitcnt vmcnt(16)
    v_lshlrev_b32 v26, 16, v220
    v_and_b32_e64 v27, s79, v220
    v_lshlrev_b32 v28, 16, v221
    v_and_b32 v29, s79, v221
    v_lshlrev_b32 v30, 16, v222
    v_and_b32 v31, s79, v222
    v_lshlrev_b32 v32, 16, v223
    v_and_b32 v33, s79, v223
    v_fmac_f32_dpp v8, v18, v26 row_newbcast:4 row_mask:0xf bank_mask:0xf
    v_fmac_f32_dpp v9, v18, v27 row_newbcast:4 row_mask:0xf bank_mask:0xf
    v_fmac_f32_dpp v10, v18, v28 row_newbcast:4 row_mask:0xf bank_mask:0xf
    v_fmac_f32_dpp v11, v18, v29 row_newbcast:4 row_mask:0xf bank_mask:0xf
    v_fmac_f32_dpp v12, v18, v30 row_newbcast:4 row_mask:0xf bank_mask:0xf
    v_fmac_f32_dpp v13, v18, v31 row_newbcast:4 row_mask:0xf bank_mask:0xf
    v_fmac_f32_dpp v14, v18, v32 row_newbcast:4 row_mask:0xf bank_mask:0xf
    v_fmac_f32_dpp v15, v18, v33 row_newbcast:4 row_mask:0xf bank_mask:0xf
    s_waitcnt vmcnt(15)
    v_lshlrev_b32 v26, 16, v224
    v_and_b32_e64 v27, s79, v224
    v_lshlrev_b32 v28, 16, v225
    v_and_b32 v29, s79, v225
    v_lshlrev_b32 v30, 16, v226
    v_and_b32 v31, s79, v226
    v_lshlrev_b32 v32, 16, v227
    v_and_b32 v33, s79, v227
    v_fmac_f32_dpp v8, v18, v26 row_newbcast:8 row_mask:0xf bank_mask:0xf
    v_fmac_f32_dpp v9, v18, v27 row_newbcast:8 row_mask:0xf bank_mask:0xf
    v_fmac_f32_dpp v10, v18, v28 row_newbcast:8 row_mask:0xf bank_mask:0xf
    v_fmac_f32_dpp v11, v18, v29 row_newbcast:8 row_mask:0xf bank_mask:0xf
    v_fmac_f32_dpp v12, v18, v30 row_newbcast:8 row_mask:0xf bank_mask:0xf
    v_fmac_f32_dpp v13, v18, v31 row_newbcast:8 row_mask:0xf bank_mask:0xf
    v_fmac_f32_dpp v14, v18, v32 row_newbcast:8 row_mask:0xf bank_mask:0xf
    v_fmac_f32_dpp v15, v18, v33 row_newbcast:8 row_mask:0xf bank_mask:0xf
    s_waitcnt vmcnt(14)
    v_lshlrev_b32 v26, 16, v228
    v_and_b32_e64 v27, s79, v228
    v_lshlrev_b32 v28, 16, v229
    v_and_b32 v29, s79, v229
    v_lshlrev_b32 v30, 16, v230
    v_and_b32 v31, s79, v230
    v_lshlrev_b32 v32, 16, v231
    v_and_b32 v33, s79, v231
    v_fmac_f32_dpp v8, v18, v26 row_newbcast:12 row_mask:0xf bank_mask:0xf
    v_fmac_f32_dpp v9, v18, v27 row_newbcast:12 row_mask:0xf bank_mask:0xf
    v_fmac_f32_dpp v10, v18, v28 row_newbcast:12 row_mask:0xf bank_mask:0xf
    v_fmac_f32_dpp v11, v18, v29 row_newbcast:12 row_mask:0xf bank_mask:0xf
    v_fmac_f32_dpp v12, v18, v30 row_newbcast:12 row_mask:0xf bank_mask:0xf
    v_fmac_f32_dpp v13, v18, v31 row_newbcast:12 row_mask:0xf bank_mask:0xf
    v_fmac_f32_dpp v14, v18, v32 row_newbcast:12 row_mask:0xf bank_mask:0xf
    v_fmac_f32_dpp v15, v18, v33 row_newbcast:12 row_mask:0xf bank_mask:0xf
    buffer_load_dwordx4 v[216:219], v1, s[32:35], s95 offen offset:0 nt
    buffer_load_dwordx4 v[220:223], v1, s[32:35], s95 offen offset:1024 nt
    buffer_load_dwordx4 v[224:227], v1, s[32:35], s95 offen offset:2048 nt
    buffer_load_dwordx4 v[228:231], v1, s[32:35], s95 offen offset:3072 nt
    s_branch L_loop
L_done:
    s_setprio 3
    v_mov_b32 v29, v36
    v_mov_b32 v28, v36
    ds_write_b64 v37, v[28:29] offset:2592
    ds_write_b32 v37, v28 offset:2600
    v_permlane32_swap_b32 v8, v12
    v_permlane32_swap_b32 v9, v13
    v_permlane32_swap_b32 v10, v14
    v_permlane32_swap_b32 v11, v15
    v_add_f32 v8, v8, v12
    v_add_f32 v9, v9, v13
    v_add_f32 v10, v10, v14
    v_add_f32 v11, v11, v15
    s_nop 0
    v_permlane16_swap_b32 v8, v10
    v_permlane16_swap_b32 v9, v11
    v_add_f32 v8, v8, v10
    v_add_f32 v9, v9, v11
    ds_write_b64 v38, v[8:9] offset:12288
    s_lshl_b32 s83, s3, 3
    v_mov_b32 v26, s83
    v_mov_b32 v27, 1
    v_mov_b32 v12, 512
    v_add_f32_dpp v17, v17, v17 row_half_mirror row_mask:0xf bank_mask:0xf
    v_cmp_eq_u32 vcc, 0, v2
    s_nop 1
    v_cndmask_b32 v12, v36, v12, vcc
    v_add_f32_dpp v17, v17, v17 row_mirror row_mask:0xf bank_mask:0xf
    v_mov_b32 v23, v17
    s_nop 1
    v_permlane32_swap_b32 v17, v23
    v_add_f32 v17, v17, v23
    v_mov_b32 v23, v17
    s_nop 1
    v_permlane16_swap_b32 v17, v23
    v_add_f32 v17, v17, v23
    s_mov_b64 exec, 1
    ds_write_b64 v26, v[16:17] offset:16384
    ds_add_rtn_u32 v13, v37, v27 offset:2568
    s_mov_b64 exec, -1
    s_lshl_b32 s83, s69, 10
    ds_read_b128 v[18:21], v37 offset:16384
    ds_read_b128 v[22:25], v37 offset:16400
    ds_read_b64 v[26:27], v39 offset:12288
    ds_read_b64 v[28:29], v39 offset:12800
    ds_read_b64 v[30:31], v39 offset:13312
    ds_read_b64 v[32:33], v39 offset:13824
    s_waitcnt lgkmcnt(4)
    v_max3_f32 v10, v18, v20, v22
    v_readfirstlane_b32 s82, v13
    v_max_f32 v10, v10, v24
    v_sub_f32 v18, v18, v10
    v_sub_f32 v20, v20, v10
    v_sub_f32 v22, v22, v10
    v_sub_f32 v24, v24, v10
    v_mul_f32 v18, s77, v18
    v_mul_f32 v20, s77, v20
    v_mul_f32 v22, s77, v22
    v_mul_f32 v24, s77, v24
    v_exp_f32 v18, v18
    v_exp_f32 v20, v20
    v_exp_f32 v22, v22
    v_exp_f32 v24, v24
    s_waitcnt lgkmcnt(0)
    s_cmp_lg_u32 s82, 3
    s_cbranch_scc1 L_fin
    v_mul_f32 v8, v18, v26
    v_mul_f32 v9, v18, v27
    v_mul_f32 v11, v18, v19
    v_fmac_f32 v8, v20, v28
    v_fmac_f32 v9, v20, v29
    v_fmac_f32 v11, v20, v21
    v_fmac_f32 v8, v22, v30
    v_fmac_f32 v9, v22, v31
    v_fmac_f32 v11, v22, v23
    v_fmac_f32 v8, v24, v32
    v_fmac_f32 v9, v24, v33
    v_fmac_f32 v11, v24, v25
    v_min_u32 v8, 0xfffffffe, v8
    v_min_u32 v9, 0xfffffffe, v9
    v_min_u32 v10, 0xfffffffe, v10
    v_min_u32 v11, 0xfffffffe, v11
    buffer_store_dwordx2 v[8:9], v39, s[44:47], s83 offen sc1
    buffer_store_dwordx2 v[10:11], v12, s[44:47], s83 offen sc1
    s_branch L_fin
    s_nop 0
L_helper:
    s_setprio 3
    s_mov_b32 s40, s4
    s_and_b32 s41, s5, 0xffff
    s_mov_b32 s42, 0x480
    s_mov_b32 s43, 0x20000
    buffer_load_dword v204, v3, s[40:43], 0 offen offset:0
    buffer_load_dword v205, v3, s[40:43], 0 offen offset:256
    buffer_load_dword v206, v3, s[40:43], 0 offen offset:512
    buffer_load_dword v207, v3, s[40:43], 0 offen offset:768
    buffer_load_dword v208, v3, s[40:43], 0 offen offset:1024
    s_mov_b32 s36, s10
    s_and_b32 s37, s11, 0xffff
    s_mov_b32 s38, 0x480000
    s_mov_b32 s39, 0x20000
    s_add_u32 s96, s26, 0xf8000
    s_addc_u32 s97, s27, 0
    s_load_dwordx2 s[98:99], s[96:97], 0
    s_lshl_b32 s83, s88, 2
    v_add_u32 v31, s83, v34
    s_mul_i32 s83, s73, 72
    v_lshl_add_u32 v32, v31, 2, s83
    v_lshlrev_b32 v33, 13, v32
    v_lshl_add_u32 v33, v35, 4, v33
    s_lshl_b32 s84, s68, 8
    buffer_load_dwordx4 v[40:43], v33, s[36:39], s84 offen
    s_add_u32 s84, s84, 8192
    buffer_load_dwordx4 v[44:47], v33, s[36:39], s84 offen
    s_add_u32 s84, s84, 8192
    buffer_load_dwordx4 v[48:51], v33, s[36:39], s84 offen
    s_add_u32 s84, s84, 8192
    buffer_load_dwordx4 v[52:55], v33, s[36:39], s84 offen
    s_add_u32 s83, s83, 64
    v_add_u32 v31, s83, v31
    v_lshlrev_b32 v33, 13, v31
    v_lshl_add_u32 v33, v35, 4, v33
    s_lshl_b32 s84, s68, 8
    s_cmp_lt_u32 s88, 2
    s_cselect_b32 s84, s84, 0x10000000
    buffer_load_dwordx4 v[56:59], v33, s[36:39], s84 offen
    s_mov_b32 s77, 0x3fb8aa3b
    s_mov_b32 s79, 0xffff0000
    v_lshlrev_b32 v38, 5, v35
    v_lshl_add_u32 v38, v34, 3, v38
    s_lshl_b32 s83, s88, 9
    v_add_u32 v38, s83, v38
    v_lshlrev_b32 v39, 3, v2
    s_mov_b32 s44, s26
    s_and_b32 s45, s27, 0xffff
    s_mov_b32 s46, 0x200000
    s_mov_b32 s47, 0x20000
    s_mov_b32 s70, 0
    s_mov_b32 s71, s2
    s_cmp_ge_u32 s2, 72
    s_cselect_b32 s70, 1, s70
    s_cmp_ge_u32 s2, 216
    s_cselect_b32 s70, 2, s70
    s_cmp_ge_u32 s2, 252
    s_cselect_b32 s70, 3, s70
    s_sub_u32 s83, s2, 72
    s_and_b32 s84, s83, 7
    s_mul_i32 s84, s84, 18
    s_lshr_b32 s83, s83, 3
    s_add_u32 s83, s83, s84
    s_cmp_eq_u32 s70, 1
    s_cselect_b32 s71, s83, s71
    s_sub_u32 s83, s2, 216
    s_cmp_eq_u32 s70, 2
    s_cselect_b32 s71, s83, s71
    v_mov_b32 v212, -1
    v_mov_b32 v213, -1
    v_mov_b32 v214, -1
    v_mov_b32 v215, -1
    s_and_b32 s83, s2, 7
    s_mul_i32 s83, s83, 2304
    s_lshr_b32 s84, s2, 3
    s_lshl_b32 s84, s84, 8
    s_add_u32 s83, s83, s84
    s_add_u32 s83, s83, 0x3fc00
    s_mul_i32 s84, s71, 2304
    s_add_u32 s84, s84, 0x63c00
    s_mov_b32 s85, 0
    s_cmp_eq_u32 s70, 0
    s_cselect_b32 s85, 1280, s85
    s_cmp_eq_u32 s70, 1
    s_cselect_b32 s85, 3328, s85
    s_cselect_b32 s83, s84, s83
    s_lshl_b32 s84, s69, 10
    s_cmp_eq_u32 s88, 0
    s_cselect_b32 s83, s84, s83
    s_cselect_b32 s85, 784, s85
    s_lshl_b32 s84, s88, 10
    v_add_u32 v216, s84, v1
    v_cmp_gt_u32 vcc, s85, v216
    s_nop 1
    v_cndmask_b32 v216, v36, v216, vcc
    s_sub_u32 s84, s88, 1
    s_lshl_b32 s85, s84, 2
    v_add_u32 v217, s85, v34
    v_mul_u32_u24 v217, 18432, v217
    v_lshl_add_u32 v217, v35, 4, v217
    v_add_u32 v217, 1024, v217
    s_lshl_b32 s85, s70, 2
    s_or_b32 s84, s84, s85
    s_cmp_lt_u32 s84, 2
    s_cselect_b64 vcc, -1, 0
    v_cndmask_b32 v216, v216, v217, vcc
    buffer_store_dwordx4 v[212:215], v216, s[44:47], s83 offen sc1
    v_cmp_gt_u32 s[80:81], 32, v2
    v_lshlrev_b32 v32, 1, v32
    v_lshlrev_b32 v31, 1, v31
    s_waitcnt vmcnt(6)
    ds_write_b32 v3, v204 offset:1280
    v_and_b32 v9, 0xffff0000, v204
    v_lshlrev_b32 v204, 16, v204
    ds_write_b32 v3, v205 offset:1536
    v_and_b32 v10, 0xffff0000, v205
    v_lshlrev_b32 v205, 16, v205
    ds_write_b32 v3, v206 offset:1792
    v_and_b32 v11, 0xffff0000, v206
    v_lshlrev_b32 v206, 16, v206
    ds_write_b32 v3, v207 offset:2048
    v_and_b32 v12, 0xffff0000, v207
    v_lshlrev_b32 v207, 16, v207
    ds_write_b32 v3, v208 offset:2304
    v_and_b32 v13, 0xffff0000, v208
    v_lshlrev_b32 v208, 16, v208
    v_add_f32 v26, v204, v205
    v_add_f32 v26, v26, v206
    v_add_f32 v26, v26, v207
    v_add_f32 v26, v26, v208
    v_add_f32 v26, v26, v9
    v_add_f32 v26, v26, v10
    v_add_f32 v26, v26, v11
    v_add_f32 v26, v26, v12
    v_add_f32 v26, v26, v13
    s_nop 1
    v_add_f32_dpp v26, v26, v26 quad_perm:[1,0,3,2] row_mask:0xf bank_mask:0xf
    s_nop 1
    v_add_f32_dpp v26, v26, v26 quad_perm:[2,3,0,1] row_mask:0xf bank_mask:0xf
    s_nop 1
    v_add_f32_dpp v26, v26, v26 row_half_mirror row_mask:0xf bank_mask:0xf
    s_nop 1
    v_add_f32_dpp v26, v26, v26 row_mirror row_mask:0xf bank_mask:0xf
    v_mov_b32 v27, v26
    s_nop 1
    v_permlane32_swap_b32 v26, v27
    v_add_f32 v26, v26, v27
    v_mov_b32 v27, v26
    s_nop 1
    v_permlane16_swap_b32 v26, v27
    v_add_f32 v26, v26, v27
    v_mul_f32 v26, 0x3ae38e39, v26
    v_mov_b32 v28, 0
    v_sub_f32 v27, v204, v26
    v_fmac_f32 v28, v27, v27
    v_sub_f32 v27, v205, v26
    v_fmac_f32 v28, v27, v27
    v_sub_f32 v27, v206, v26
    v_fmac_f32 v28, v27, v27
    v_sub_f32 v27, v207, v26
    v_fmac_f32 v28, v27, v27
    v_sub_f32 v27, v208, v26
    v_cndmask_b32 v27, 0, v27, s[80:81]
    v_fmac_f32 v28, v27, v27
    v_sub_f32 v27, v9, v26
    v_fmac_f32 v28, v27, v27
    v_sub_f32 v27, v10, v26
    v_fmac_f32 v28, v27, v27
    v_sub_f32 v27, v11, v26
    v_fmac_f32 v28, v27, v27
    v_sub_f32 v27, v12, v26
    v_fmac_f32 v28, v27, v27
    v_sub_f32 v27, v13, v26
    v_cndmask_b32 v27, 0, v27, s[80:81]
    v_fmac_f32 v28, v27, v27
    s_nop 1
    v_add_f32_dpp v28, v28, v28 quad_perm:[1,0,3,2] row_mask:0xf bank_mask:0xf
    s_nop 1
    v_add_f32_dpp v28, v28, v28 quad_perm:[2,3,0,1] row_mask:0xf bank_mask:0xf
    s_nop 1
    v_add_f32_dpp v28, v28, v28 row_half_mirror row_mask:0xf bank_mask:0xf
    s_nop 1
    v_add_f32_dpp v28, v28, v28 row_mirror row_mask:0xf bank_mask:0xf
    v_mov_b32 v27, v28
    s_nop 1
    v_permlane32_swap_b32 v28, v27
    v_add_f32 v28, v28, v27
    v_mov_b32 v27, v28
    s_nop 1
    v_permlane16_swap_b32 v28, v27
    v_add_f32 v28, v28, v27
    v_mul_f32 v28, 0x3ae38e39, v28
    v_cvt_pk_bf16_f32 v26, v26, v26
    v_and_b32 v26, 0xffff0000, v26
    v_cvt_pk_bf16_f32 v28, v28, v28
    v_and_b32 v28, 0xffff0000, v28
    v_add_f32 v28, 0x3727c5ac, v28
    v_cvt_pk_bf16_f32 v28, v28, v28
    v_and_b32 v28, 0xffff0000, v28
    v_sqrt_f32 v28, v28
    s_nop 0
    v_cvt_pk_bf16_f32 v28, v28, v28
    v_and_b32 v28, 0xffff0000, v28
    v_rcp_f32 v28, v28
    v_sub_f32 v204, v204, v26
    v_sub_f32 v9, v9, v26
    v_cvt_pk_bf16_f32 v22, v204, v9
    v_lshlrev_b32 v204, 16, v22
    v_and_b32 v9, 0xffff0000, v22
    v_mul_f32 v204, v204, v28
    v_mul_f32 v9, v9, v28
    v_cvt_pk_bf16_f32 v22, v204, v9
    ds_write_b32 v3, v22 offset:0
    v_sub_f32 v205, v205, v26
    v_sub_f32 v10, v10, v26
    v_cvt_pk_bf16_f32 v22, v205, v10
    v_lshlrev_b32 v205, 16, v22
    v_and_b32 v10, 0xffff0000, v22
    v_mul_f32 v205, v205, v28
    v_mul_f32 v10, v10, v28
    v_cvt_pk_bf16_f32 v22, v205, v10
    ds_write_b32 v3, v22 offset:256
    v_sub_f32 v206, v206, v26
    v_sub_f32 v11, v11, v26
    v_cvt_pk_bf16_f32 v22, v206, v11
    v_lshlrev_b32 v206, 16, v22
    v_and_b32 v11, 0xffff0000, v22
    v_mul_f32 v206, v206, v28
    v_mul_f32 v11, v11, v28
    v_cvt_pk_bf16_f32 v22, v206, v11
    ds_write_b32 v3, v22 offset:512
    v_sub_f32 v207, v207, v26
    v_sub_f32 v12, v12, v26
    v_cvt_pk_bf16_f32 v22, v207, v12
    v_lshlrev_b32 v207, 16, v22
    v_and_b32 v12, 0xffff0000, v22
    v_mul_f32 v207, v207, v28
    v_mul_f32 v12, v12, v28
    v_cvt_pk_bf16_f32 v22, v207, v12
    ds_write_b32 v3, v22 offset:768
    v_sub_f32 v208, v208, v26
    v_sub_f32 v13, v13, v26
    v_cvt_pk_bf16_f32 v22, v208, v13
    v_lshlrev_b32 v208, 16, v22
    v_and_b32 v13, 0xffff0000, v22
    v_mul_f32 v208, v208, v28
    v_mul_f32 v13, v13, v28
    v_cvt_pk_bf16_f32 v22, v208, v13
    ds_write_b32 v3, v22 offset:1024
    s_waitcnt lgkmcnt(0)
    ds_read_b64 v[184:185], v32 offset:0
    ds_read_u16 v186, v31 offset:0
    v_mov_b32 v14, 0
    v_mov_b32 v15, 0
    v_mov_b32 v16, 0
    v_mov_b32 v17, 0
    v_mov_b32 v18, 0
    v_mov_b32 v19, 0
    v_mov_b32 v20, 0
    v_mov_b32 v21, 0
    s_add_u32 s98, s98, 1
    s_lshl_b32 s96, s68, 13
    s_add_u32 s96, s96, 0xb8000
    s_lshl_b32 s97, s73, 10
    s_add_u32 s97, s97, s96
    s_waitcnt lgkmcnt(0)
    v_and_b32 v22, 0xffff, v184
    v_lshlrev_b32 v23, 16, v184
    s_waitcnt vmcnt(5)
    v_dot2c_f32_bf16 v14, v40, v22
    v_dot2c_f32_bf16 v15, v40, v23
    v_dot2c_f32_bf16 v16, v41, v22
    v_dot2c_f32_bf16 v17, v41, v23
    v_dot2c_f32_bf16 v18, v42, v22
    v_dot2c_f32_bf16 v19, v42, v23
    v_dot2c_f32_bf16 v20, v43, v22
    v_dot2c_f32_bf16 v21, v43, v23
    v_lshrrev_b32 v22, 16, v184
    v_and_b32 v23, 0xffff0000, v184
    s_waitcnt vmcnt(4)
    v_dot2c_f32_bf16 v14, v44, v22
    v_dot2c_f32_bf16 v15, v44, v23
    v_dot2c_f32_bf16 v16, v45, v22
    v_dot2c_f32_bf16 v17, v45, v23
    v_dot2c_f32_bf16 v18, v46, v22
    v_dot2c_f32_bf16 v19, v46, v23
    v_dot2c_f32_bf16 v20, v47, v22
    v_dot2c_f32_bf16 v21, v47, v23
    v_and_b32 v22, 0xffff, v185
    v_lshlrev_b32 v23, 16, v185
    s_waitcnt vmcnt(3)
    v_dot2c_f32_bf16 v14, v48, v22
    v_dot2c_f32_bf16 v15, v48, v23
    v_dot2c_f32_bf16 v16, v49, v22
    v_dot2c_f32_bf16 v17, v49, v23
    v_dot2c_f32_bf16 v18, v50, v22
    v_dot2c_f32_bf16 v19, v50, v23
    v_dot2c_f32_bf16 v20, v51, v22
    v_dot2c_f32_bf16 v21, v51, v23
    v_lshrrev_b32 v22, 16, v185
    v_and_b32 v23, 0xffff0000, v185
    s_waitcnt vmcnt(2)
    v_dot2c_f32_bf16 v14, v52, v22
    v_dot2c_f32_bf16 v15, v52, v23
    v_dot2c_f32_bf16 v16, v53, v22
    v_dot2c_f32_bf16 v17, v53, v23
    v_dot2c_f32_bf16 v18, v54, v22
    v_dot2c_f32_bf16 v19, v54, v23
    v_dot2c_f32_bf16 v20, v55, v22
    v_dot2c_f32_bf16 v21, v55, v23
    v_and_b32 v22, 0xffff, v186
    v_lshlrev_b32 v23, 16, v186
    s_waitcnt vmcnt(1)
    v_dot2c_f32_bf16 v14, v56, v22
    v_dot2c_f32_bf16 v15, v56, v23
    v_dot2c_f32_bf16 v16, v57, v22
    v_dot2c_f32_bf16 v17, v57, v23
    v_dot2c_f32_bf16 v18, v58, v22
    v_dot2c_f32_bf16 v19, v58, v23
    v_dot2c_f32_bf16 v20, v59, v22
    v_dot2c_f32_bf16 v21, v59, v23
    v_permlane32_swap_b32 v14, v18
    v_permlane32_swap_b32 v15, v19
    v_permlane32_swap_b32 v16, v20
    v_permlane32_swap_b32 v17, v21
    v_add_f32 v14, v14, v18
    v_add_f32 v15, v15, v19
    v_add_f32 v16, v16, v20
    v_add_f32 v17, v17, v21
    s_nop 0
    v_permlane16_swap_b32 v14, v16
    v_permlane16_swap_b32 v15, v17
    v_add_f32 v14, v14, v16
    v_add_f32 v15, v15, v17
    ds_write_b64 v38, v[14:15] offset:4096
    v_mov_b32 v23, 1
    s_mov_b64 exec, 1
    ds_add_rtn_u32 v24, v37, v23 offset:2560
    s_mov_b64 exec, -1
    s_waitcnt lgkmcnt(0)
    v_readfirstlane_b32 s82, v24
    s_cmp_lg_u32 s82, 3
    s_nop 3
    s_cbranch_scc1 L_qdone
    ds_read_b64 v[4:5], v39 offset:4096
    ds_read_b64 v[6:7], v39 offset:4608
    ds_read_b64 v[8:9], v39 offset:5120
    ds_read_b64 v[10:11], v39 offset:5632
    s_waitcnt lgkmcnt(0)
    v_add_f32 v4, v4, v6
    v_add_f32 v8, v8, v10
    v_add_f32 v5, v5, v7
    v_add_f32 v9, v9, v11
    v_add_f32 v4, v4, v8
    v_add_f32 v5, v5, v9
    v_mov_b32 v6, s98
    v_mov_b32 v7, s99
    buffer_store_dwordx4 v[4:7], v1, s[44:47], s97 offen sc1
    s_add_u32 s97, s96, 4096
    s_mov_b32 s76, 0
L_qx:
    buffer_load_dwordx4 v[64:67], v1, s[44:47], s96 offen offset:0 sc1
    buffer_load_dwordx4 v[68:71], v1, s[44:47], s96 offen offset:1024 sc1
    buffer_load_dwordx4 v[72:75], v1, s[44:47], s96 offen offset:2048 sc1
    buffer_load_dwordx4 v[76:79], v1, s[44:47], s96 offen offset:3072 sc1
    buffer_load_dwordx4 v[80:83], v1, s[44:47], s97 offen offset:0 sc1
    buffer_load_dwordx4 v[84:87], v1, s[44:47], s97 offen offset:1024 sc1
    buffer_load_dwordx4 v[88:91], v1, s[44:47], s97 offen offset:2048 sc1
    buffer_load_dwordx4 v[92:95], v1, s[44:47], s97 offen offset:3072 sc1
    v_mov_b32 v24, 0
    s_waitcnt vmcnt(7)
    v_xor_b32 v66, s98, v66
    v_xor_b32 v67, s99, v67
    v_or3_b32 v24, v24, v66, v67
    s_waitcnt vmcnt(6)
    v_xor_b32 v70, s98, v70
    v_xor_b32 v71, s99, v71
    v_or3_b32 v24, v24, v70, v71
    s_waitcnt vmcnt(5)
    v_xor_b32 v74, s98, v74
    v_xor_b32 v75, s99, v75
    v_or3_b32 v24, v24, v74, v75
    s_waitcnt vmcnt(4)
    v_xor_b32 v78, s98, v78
    v_xor_b32 v79, s99, v79
    v_or3_b32 v24, v24, v78, v79
    s_waitcnt vmcnt(3)
    v_xor_b32 v82, s98, v82
    v_xor_b32 v83, s99, v83
    v_or3_b32 v24, v24, v82, v83
    s_waitcnt vmcnt(2)
    v_xor_b32 v86, s98, v86
    v_xor_b32 v87, s99, v87
    v_or3_b32 v24, v24, v86, v87
    s_waitcnt vmcnt(1)
    v_xor_b32 v90, s98, v90
    v_xor_b32 v91, s99, v91
    v_or3_b32 v24, v24, v90, v91
    s_waitcnt vmcnt(0)
    v_xor_b32 v94, s98, v94
    v_xor_b32 v95, s99, v95
    v_or3_b32 v24, v24, v94, v95
    v_cmp_ne_u32 vcc, 0, v24
    s_nop 4
    s_cbranch_vccz L_qx_ok
    s_add_u32 s76, s76, 1
    s_cmp_gt_u32 s76, 30000
    s_cbranch_scc1 L_qx_ok
    s_sleep 2
    s_branch L_qx
L_qx_ok:
    v_add_f32 v64, v64, v80
    v_add_f32 v65, v65, v81
    v_add_f32 v68, v68, v84
    v_add_f32 v69, v69, v85
    v_add_f32 v72, v72, v88
    v_add_f32 v73, v73, v89
    v_add_f32 v76, v76, v92
    v_add_f32 v77, v77, v93
    v_add_f32 v64, v64, v72
    v_add_f32 v65, v65, v73
    v_add_f32 v68, v68, v76
    v_add_f32 v69, v69, v77
    v_add_f32 v64, v64, v68
    v_add_f32 v65, v65, v69
    v_cvt_pk_bf16_f32 v4, v64, v65
    ds_write_b32 v3, v4 offset:8192
    ds_write_b32 v37, v23 offset:2564
L_qdone:
    s_mov_b32 s48, s12
    s_and_b32 s49, s13, 0xffff
    s_mov_b32 s50, 0x480000
    s_mov_b32 s51, 0x20000
    s_cmp_ge_u32 s3, 6
    s_cselect_b32 s16, s18, s16
    s_cselect_b32 s17, s19, s17
    s_mov_b32 s52, s16
    s_and_b32 s53, s17, 0xffff
    s_mov_b32 s54, 0x510000
    s_mov_b32 s55, 0x20000
    s_mov_b32 s56, s20
    s_and_b32 s57, s21, 0xffff
    s_mov_b32 s58, 0x510000
    s_mov_b32 s59, 0x20000
    s_mov_b32 s60, s22
    s_and_b32 s61, s23, 0xffff
    s_mov_b32 s62, 0x480
    s_mov_b32 s63, 0x20000
    s_mov_b32 s64, s24
    s_and_b32 s65, s25, 0xffff
    s_mov_b32 s66, 0x100
    s_mov_b32 s67, 0x20000
    s_mov_b32 s4, s8
    s_and_b32 s8, s2, 7
    s_mul_i32 s8, s8, 18432
    s_add_u32 s8, s8, 0x40000
    s_mov_b32 s86, 0x05040100
    s_mov_b32 s87, 0x07060302
    v_cmp_eq_u32 vcc, 0, v2
    s_nop 1
    v_cndmask_b32 v25, v36, v37, vcc
    s_waitcnt vmcnt(0)
    s_mov_b64 exec, 1
    ds_add_rtn_u32 v24, v37, v23 offset:2572
    s_mov_b64 exec, -1
    s_waitcnt lgkmcnt(0)
    v_readfirstlane_b32 s82, v24
    s_cmp_lg_u32 s82, 3
    s_nop 3
    s_cbranch_scc1 L_nocount
    buffer_atomic_add v23, v25, s[64:67], 0 offen sc1
L_nocount:
    s_cmp_lg_u32 s3, 4
    s_cbranch_scc1 L_cnt_skip
    s_sleep 64
    s_sleep 64
    s_sleep 64
    s_sleep 64
    s_sleep 64
    s_mov_b32 s76, 0
L_cnt:
    buffer_load_dword v33, v37, s[64:67], 0 offen sc1
    s_waitcnt vmcnt(0)
    v_readfirstlane_b32 s84, v33
    s_sub_u32 s84, s84, 1
    s_and_b32 s84, s84, 0x800000ff
    s_cmp_eq_u32 s84, 255
    s_nop 1
    s_cbranch_scc1 L_cnt_ok
    s_add_u32 s76, s76, 1
    s_cmp_gt_u32 s76, 3750
    s_cbranch_scc1 L_cnt_ok
    s_sleep 48
    s_branch L_cnt
L_cnt_ok:
    v_mov_b32 v33, 4
    ds_write_b32 v37, v33 offset:2576
    s_nop 0
L_cnt_skip:
    s_cmp_eq_u32 s70, 3
    s_cbranch_scc1 L_fin
    s_mov_b32 s72, 1
    s_cmp_eq_u32 s70, 1
    s_cbranch_scc1 L_roleM
    s_cmp_eq_u32 s70, 2
    s_cbranch_scc1 L_roleF
    s_and_b32 s82, s2, 7
    s_lshl_b32 s84, s88, 3
    s_add_u32 s82, s82, s84
    s_mul_i32 s83, s82, 147456
    s_lshr_b32 s84, s2, 3
    s_lshl_b32 s84, s84, 7
    s_add_u32 s83, s83, s84
    v_mul_u32_u24 v30, 36864, v34
    v_lshl_add_u32 v30, v35, 3, v30
    buffer_load_dwordx2 v[40:41], v30, s[48:51], s83 offen offset:0 nt
    buffer_load_dwordx2 v[42:43], v30, s[48:51], s83 offen offset:1152 nt
    buffer_load_dwordx2 v[44:45], v30, s[48:51], s83 offen offset:2304 nt
    s_add_u32 s83, s83, 3456
    buffer_load_dwordx2 v[46:47], v30, s[48:51], s83 offen offset:0 nt
    buffer_load_dwordx2 v[48:49], v30, s[48:51], s83 offen offset:1152 nt
    buffer_load_dwordx2 v[50:51], v30, s[48:51], s83 offen offset:2304 nt
    s_add_u32 s83, s83, 3456
    buffer_load_dwordx2 v[52:53], v30, s[48:51], s83 offen offset:0 nt
    buffer_load_dwordx2 v[54:55], v30, s[48:51], s83 offen offset:1152 nt
    buffer_load_dwordx2 v[56:57], v30, s[48:51], s83 offen offset:2304 nt
    s_add_u32 s83, s83, 3456
    buffer_load_dwordx2 v[58:59], v30, s[48:51], s83 offen offset:0 nt
    buffer_load_dwordx2 v[60:61], v30, s[48:51], s83 offen offset:1152 nt
    buffer_load_dwordx2 v[62:63], v30, s[48:51], s83 offen offset:2304 nt
    s_add_u32 s83, s83, 3456
    buffer_load_dwordx2 v[64:65], v30, s[48:51], s83 offen offset:0 nt
    buffer_load_dwordx2 v[66:67], v30, s[48:51], s83 offen offset:1152 nt
    buffer_load_dwordx2 v[68:69], v30, s[48:51], s83 offen offset:2304 nt
    s_add_u32 s83, s83, 3456
    buffer_load_dwordx2 v[70:71], v30, s[48:51], s83 offen offset:0 nt
    buffer_load_dwordx2 v[72:73], v30, s[48:51], s83 offen offset:1152 nt
    buffer_load_dwordx2 v[74:75], v30, s[48:51], s83 offen offset:2304 nt
    s_add_u32 s83, s83, 3456
    buffer_load_dwordx2 v[76:77], v30, s[48:51], s83 offen offset:0 nt
    buffer_load_dwordx2 v[78:79], v30, s[48:51], s83 offen offset:1152 nt
    buffer_load_dwordx2 v[80:81], v30, s[48:51], s83 offen offset:2304 nt
    s_add_u32 s83, s83, 3456
    buffer_load_dwordx2 v[82:83], v30, s[48:51], s83 offen offset:0 nt
    buffer_load_dwordx2 v[84:85], v30, s[48:51], s83 offen offset:1152 nt
    buffer_load_dwordx2 v[86:87], v30, s[48:51], s83 offen offset:2304 nt
    s_add_u32 s83, s83, 3456
    s_waitcnt vmcnt(23)
    buffer_load_dwordx2 v[88:89], v30, s[48:51], s83 offen offset:0 nt
    s_waitcnt vmcnt(23)
    buffer_load_dwordx2 v[90:91], v30, s[48:51], s83 offen offset:1152 nt
    s_waitcnt vmcnt(23)
    buffer_load_dwordx2 v[92:93], v30, s[48:51], s83 offen offset:2304 nt
    s_add_u32 s83, s83, 3456
    s_waitcnt vmcnt(23)
    buffer_load_dwordx2 v[94:95], v30, s[48:51], s83 offen offset:0 nt
    s_waitcnt vmcnt(23)
    buffer_load_dwordx2 v[96:97], v30, s[48:51], s83 offen offset:1152 nt
    s_waitcnt vmcnt(23)
    buffer_load_dwordx2 v[98:99], v30, s[48:51], s83 offen offset:2304 nt
    s_add_u32 s83, s83, 3456
    s_waitcnt vmcnt(23)
    buffer_load_dwordx2 v[100:101], v30, s[48:51], s83 offen offset:0 nt
    s_waitcnt vmcnt(23)
    buffer_load_dwordx2 v[102:103], v30, s[48:51], s83 offen offset:1152 nt
    s_lshl_b32 s82, s82, 10
    v_mov_b32 v30, s82
    v_add_u32 v31, s82, v39
    s_mov_b32 s90, 0
    s_mov_b32 s91, 32768
    s_mov_b32 s92, 65536
    s_mov_b32 s93, 98304
    s_mov_b32 s94, 131072
    s_mov_b32 s95, 163840
    s_mov_b32 s96, 196608
    s_mov_b32 s97, 229376
    v_lshlrev_b32 v29, 4, v35
    v_lshl_add_u32 v29, v34, 2, v29
    s_lshl_b32 s83, s88, 8
    v_add_u32 v29, s83, v29
    s_and_b32 s83, s2, 7
    s_mul_i32 s83, s83, 2304
    s_lshl_b32 s84, s84, 1
    s_add_u32 s83, s83, s84
    s_add_u32 s83, s83, 0x40000
    s_mul_i32 s84, s88, 36864
    s_add_u32 s83, s83, s84
    s_add_u32 s85, s83, 18432
    s_waitcnt vmcnt(0)
    v_perm_b32 v26, v42, v40, s86
    v_perm_b32 v42, v42, v40, s87
    v_mov_b32 v40, v26
    v_perm_b32 v26, v43, v41, s86
    v_perm_b32 v43, v43, v41, s87
    v_mov_b32 v41, v26
    v_perm_b32 v26, v46, v44, s86
    v_perm_b32 v46, v46, v44, s87
    v_mov_b32 v44, v26
    v_perm_b32 v26, v47, v45, s86
    v_perm_b32 v47, v47, v45, s87
    v_mov_b32 v45, v26
    v_perm_b32 v26, v50, v48, s86
    v_perm_b32 v50, v50, v48, s87
    v_mov_b32 v48, v26
    v_perm_b32 v26, v51, v49, s86
    v_perm_b32 v51, v51, v49, s87
    v_mov_b32 v49, v26
    v_perm_b32 v26, v54, v52, s86
    v_perm_b32 v54, v54, v52, s87
    v_mov_b32 v52, v26
    v_perm_b32 v26, v55, v53, s86
    v_perm_b32 v55, v55, v53, s87
    v_mov_b32 v53, v26
    v_perm_b32 v26, v58, v56, s86
    v_perm_b32 v58, v58, v56, s87
    v_mov_b32 v56, v26
    v_perm_b32 v26, v59, v57, s86
    v_perm_b32 v59, v59, v57, s87
    v_mov_b32 v57, v26
    v_perm_b32 v26, v62, v60, s86
    v_perm_b32 v62, v62, v60, s87
    v_mov_b32 v60, v26
    v_perm_b32 v26, v63, v61, s86
    v_perm_b32 v63, v63, v61, s87
    v_mov_b32 v61, v26
    v_perm_b32 v26, v66, v64, s86
    v_perm_b32 v66, v66, v64, s87
    v_mov_b32 v64, v26
    v_perm_b32 v26, v67, v65, s86
    v_perm_b32 v67, v67, v65, s87
    v_mov_b32 v65, v26
    v_perm_b32 v26, v70, v68, s86
    v_perm_b32 v70, v70, v68, s87
    v_mov_b32 v68, v26
    v_perm_b32 v26, v71, v69, s86
    v_perm_b32 v71, v71, v69, s87
    v_mov_b32 v69, v26
    v_perm_b32 v26, v74, v72, s86
    v_perm_b32 v74, v74, v72, s87
    v_mov_b32 v72, v26
    v_perm_b32 v26, v75, v73, s86
    v_perm_b32 v75, v75, v73, s87
    v_mov_b32 v73, v26
    v_perm_b32 v26, v78, v76, s86
    v_perm_b32 v78, v78, v76, s87
    v_mov_b32 v76, v26
    v_perm_b32 v26, v79, v77, s86
    v_perm_b32 v79, v79, v77, s87
    v_mov_b32 v77, v26
    v_perm_b32 v26, v82, v80, s86
    v_perm_b32 v82, v82, v80, s87
    v_mov_b32 v80, v26
    v_perm_b32 v26, v83, v81, s86
    v_perm_b32 v83, v83, v81, s87
    v_mov_b32 v81, v26
    v_perm_b32 v26, v86, v84, s86
    v_perm_b32 v86, v86, v84, s87
    v_mov_b32 v84, v26
    v_perm_b32 v26, v87, v85, s86
    v_perm_b32 v87, v87, v85, s87
    v_mov_b32 v85, v26
    v_perm_b32 v26, v90, v88, s86
    v_perm_b32 v90, v90, v88, s87
    v_mov_b32 v88, v26
    v_perm_b32 v26, v91, v89, s86
    v_perm_b32 v91, v91, v89, s87
    v_mov_b32 v89, v26
    v_perm_b32 v26, v94, v92, s86
    v_perm_b32 v94, v94, v92, s87
    v_mov_b32 v92, v26
    v_perm_b32 v26, v95, v93, s86
    v_perm_b32 v95, v95, v93, s87
    v_mov_b32 v93, v26
    v_perm_b32 v26, v98, v96, s86
    v_perm_b32 v98, v98, v96, s87
    v_mov_b32 v96, v26
    v_perm_b32 v26, v99, v97, s86
    v_perm_b32 v99, v99, v97, s87
    v_mov_b32 v97, v26
    v_perm_b32 v26, v102, v100, s86
    v_perm_b32 v102, v102, v100, s87
    v_mov_b32 v100, v26
    v_perm_b32 v26, v103, v101, s86
    v_perm_b32 v103, v103, v101, s87
    v_mov_b32 v101, v26
    s_nop 1
L_o_pass:
    s_cmp_lg_u32 s72, 0
    s_cselect_b64 vcc, -1, 0
    v_cndmask_b32 v32, v3, v36, vcc
    v_mov_b32 v8, 0
    v_mov_b32 v9, 0
    v_mov_b32 v10, 0
    v_mov_b32 v11, 0
    v_mov_b32 v12, 0
    v_mov_b32 v13, 0
    v_mov_b32 v14, 0
    v_mov_b32 v15, 0
    v_lshlrev_b32 v26, 15, v2
    v_add_u32 v26, v26, v30
    v_add_u32 v26, 512, v26
    v_cmp_gt_u32 vcc, 8, v2
    s_nop 1
    v_cndmask_b32 v26, v36, v26, vcc
    s_mul_i32 s76, s72, 30000
    s_nop 0
L_o_l:
    buffer_load_dword v200, v26, s[44:47], 0 offen sc1
    s_waitcnt vmcnt(0)
    v_cmp_eq_u32 vcc, -1, v200
    s_bcnt1_i32_b64 s84, vcc
    s_cmp_le_u32 s84, 1
    s_nop 2
    s_cbranch_scc1 L_o_l_ok
    s_add_u32 s76, s76, 1
    s_cmp_gt_u32 s76, 30000
    s_cbranch_scc1 L_o_l_ok
    s_sleep 1
    s_branch L_o_l
L_o_l_ok:
    v_and_b32 v160, 7, v2
    v_lshl_add_u32 v160, v160, 15, v30
    s_mul_i32 s76, s72, 30000
    s_nop 0
L_o_o:
    buffer_load_dwordx2 v[200:201], v160, s[44:47], 0 offen offset:512 sc1
    buffer_load_dwordx2 v[216:217], v31, s[44:47], s90 offen sc1
    buffer_load_dwordx2 v[218:219], v31, s[44:47], s91 offen sc1
    buffer_load_dwordx2 v[220:221], v31, s[44:47], s92 offen sc1
    buffer_load_dwordx2 v[222:223], v31, s[44:47], s93 offen sc1
    buffer_load_dwordx2 v[224:225], v31, s[44:47], s94 offen sc1
    buffer_load_dwordx2 v[226:227], v31, s[44:47], s95 offen sc1
    buffer_load_dwordx2 v[228:229], v31, s[44:47], s96 offen sc1
    buffer_load_dwordx2 v[230:231], v31, s[44:47], s97 offen sc1
    s_waitcnt vmcnt(8)
    v_max_f32_dpp v202, v200, v200 quad_perm:[1,0,3,2] row_mask:0xf bank_mask:0xf
    s_nop 1
    v_max_f32_dpp v202, v202, v202 quad_perm:[2,3,0,1] row_mask:0xf bank_mask:0xf
    s_nop 1
    v_max_f32_dpp v202, v202, v202 row_half_mirror row_mask:0xf bank_mask:0xf
    v_sub_f32 v202, v200, v202
    v_mul_f32 v202, s77, v202
    v_exp_f32 v202, v202
    s_nop 0
    v_mul_f32 v26, v202, v201
    s_waitcnt vmcnt(7)
    v_mul_f32_dpp v27, v202, v216 row_newbcast:0 row_mask:0xf bank_mask:0xf
    v_mul_f32_dpp v28, v202, v217 row_newbcast:0 row_mask:0xf bank_mask:0xf
    v_add_f32_dpp v26, v26, v26 quad_perm:[1,0,3,2] row_mask:0xf bank_mask:0xf
    s_waitcnt vmcnt(6)
    v_fmac_f32_dpp v27, v202, v218 row_newbcast:1 row_mask:0xf bank_mask:0xf
    v_fmac_f32_dpp v28, v202, v219 row_newbcast:1 row_mask:0xf bank_mask:0xf
    v_add_f32_dpp v26, v26, v26 quad_perm:[2,3,0,1] row_mask:0xf bank_mask:0xf
    s_waitcnt vmcnt(5)
    v_fmac_f32_dpp v27, v202, v220 row_newbcast:2 row_mask:0xf bank_mask:0xf
    v_fmac_f32_dpp v28, v202, v221 row_newbcast:2 row_mask:0xf bank_mask:0xf
    v_add_f32_dpp v26, v26, v26 row_half_mirror row_mask:0xf bank_mask:0xf
    s_waitcnt vmcnt(4)
    v_fmac_f32_dpp v27, v202, v222 row_newbcast:3 row_mask:0xf bank_mask:0xf
    v_fmac_f32_dpp v28, v202, v223 row_newbcast:3 row_mask:0xf bank_mask:0xf
    v_rcp_f32 v26, v26
    s_waitcnt vmcnt(3)
    v_fmac_f32_dpp v27, v202, v224 row_newbcast:4 row_mask:0xf bank_mask:0xf
    v_fmac_f32_dpp v28, v202, v225 row_newbcast:4 row_mask:0xf bank_mask:0xf
    s_waitcnt vmcnt(2)
    v_fmac_f32_dpp v27, v202, v226 row_newbcast:5 row_mask:0xf bank_mask:0xf
    v_fmac_f32_dpp v28, v202, v227 row_newbcast:5 row_mask:0xf bank_mask:0xf
    s_waitcnt vmcnt(1)
    v_fmac_f32_dpp v27, v202, v228 row_newbcast:6 row_mask:0xf bank_mask:0xf
    v_fmac_f32_dpp v28, v202, v229 row_newbcast:6 row_mask:0xf bank_mask:0xf
    s_waitcnt vmcnt(0)
    v_fmac_f32_dpp v27, v202, v230 row_newbcast:7 row_mask:0xf bank_mask:0xf
    v_fmac_f32_dpp v28, v202, v231 row_newbcast:7 row_mask:0xf bank_mask:0xf
    v_mul_f32 v27, v27, v26
    v_mul_f32 v28, v28, v26
    v_cmp_u_f32 vcc, v27, v28
    v_cvt_pk_bf16_f32 v28, v27, v28
    s_nop 3
    s_cbranch_vccz L_o_o_ok
    s_add_u32 s76, s76, 1
    s_cmp_lt_u32 s76, 64
    s_cbranch_scc1 L_o_o
    v_max_u32 v26, v200, v201
    v_max3_u32 v26, v26, v216, v217
    v_max3_u32 v26, v26, v218, v219
    v_max3_u32 v26, v26, v220, v221
    v_max3_u32 v26, v26, v222, v223
    v_max3_u32 v26, v26, v224, v225
    v_max3_u32 v26, v26, v226, v227
    v_max3_u32 v26, v26, v228, v229
    v_max3_u32 v26, v26, v230, v231
    v_cmp_eq_u32 vcc, -1, v26
    s_nop 4
    s_cbranch_vccz L_o_o_ok
    s_cmp_le_u32 s76, 30000
    s_cbranch_scc1 L_o_o
    s_nop 0
L_o_o_ok:
    v_dot2c_f32_bf16_dpp v8, v28, v40 row_newbcast:0 row_mask:0xf bank_mask:0xf
    v_dot2c_f32_bf16_dpp v9, v28, v42 row_newbcast:0 row_mask:0xf bank_mask:0xf
    v_dot2c_f32_bf16_dpp v10, v28, v41 row_newbcast:0 row_mask:0xf bank_mask:0xf
    v_dot2c_f32_bf16_dpp v11, v28, v43 row_newbcast:0 row_mask:0xf bank_mask:0xf
    v_dot2c_f32_bf16_dpp v12, v28, v44 row_newbcast:1 row_mask:0xf bank_mask:0xf
    v_dot2c_f32_bf16_dpp v13, v28, v46 row_newbcast:1 row_mask:0xf bank_mask:0xf
    v_dot2c_f32_bf16_dpp v14, v28, v45 row_newbcast:1 row_mask:0xf bank_mask:0xf
    v_dot2c_f32_bf16_dpp v15, v28, v47 row_newbcast:1 row_mask:0xf bank_mask:0xf
    v_dot2c_f32_bf16_dpp v8, v28, v48 row_newbcast:2 row_mask:0xf bank_mask:0xf
    v_dot2c_f32_bf16_dpp v9, v28, v50 row_newbcast:2 row_mask:0xf bank_mask:0xf
    v_dot2c_f32_bf16_dpp v10, v28, v49 row_newbcast:2 row_mask:0xf bank_mask:0xf
    v_dot2c_f32_bf16_dpp v11, v28, v51 row_newbcast:2 row_mask:0xf bank_mask:0xf
    v_dot2c_f32_bf16_dpp v12, v28, v52 row_newbcast:3 row_mask:0xf bank_mask:0xf
    v_dot2c_f32_bf16_dpp v13, v28, v54 row_newbcast:3 row_mask:0xf bank_mask:0xf
    v_dot2c_f32_bf16_dpp v14, v28, v53 row_newbcast:3 row_mask:0xf bank_mask:0xf
    v_dot2c_f32_bf16_dpp v15, v28, v55 row_newbcast:3 row_mask:0xf bank_mask:0xf
    v_dot2c_f32_bf16_dpp v8, v28, v56 row_newbcast:4 row_mask:0xf bank_mask:0xf
    v_dot2c_f32_bf16_dpp v9, v28, v58 row_newbcast:4 row_mask:0xf bank_mask:0xf
    v_dot2c_f32_bf16_dpp v10, v28, v57 row_newbcast:4 row_mask:0xf bank_mask:0xf
    v_dot2c_f32_bf16_dpp v11, v28, v59 row_newbcast:4 row_mask:0xf bank_mask:0xf
    v_dot2c_f32_bf16_dpp v12, v28, v60 row_newbcast:5 row_mask:0xf bank_mask:0xf
    v_dot2c_f32_bf16_dpp v13, v28, v62 row_newbcast:5 row_mask:0xf bank_mask:0xf
    v_dot2c_f32_bf16_dpp v14, v28, v61 row_newbcast:5 row_mask:0xf bank_mask:0xf
    v_dot2c_f32_bf16_dpp v15, v28, v63 row_newbcast:5 row_mask:0xf bank_mask:0xf
    v_dot2c_f32_bf16_dpp v8, v28, v64 row_newbcast:6 row_mask:0xf bank_mask:0xf
    v_dot2c_f32_bf16_dpp v9, v28, v66 row_newbcast:6 row_mask:0xf bank_mask:0xf
    v_dot2c_f32_bf16_dpp v10, v28, v65 row_newbcast:6 row_mask:0xf bank_mask:0xf
    v_dot2c_f32_bf16_dpp v11, v28, v67 row_newbcast:6 row_mask:0xf bank_mask:0xf
    v_dot2c_f32_bf16_dpp v12, v28, v68 row_newbcast:7 row_mask:0xf bank_mask:0xf
    v_dot2c_f32_bf16_dpp v13, v28, v70 row_newbcast:7 row_mask:0xf bank_mask:0xf
    v_dot2c_f32_bf16_dpp v14, v28, v69 row_newbcast:7 row_mask:0xf bank_mask:0xf
    v_dot2c_f32_bf16_dpp v15, v28, v71 row_newbcast:7 row_mask:0xf bank_mask:0xf
    v_dot2c_f32_bf16_dpp v8, v28, v72 row_newbcast:8 row_mask:0xf bank_mask:0xf
    v_dot2c_f32_bf16_dpp v9, v28, v74 row_newbcast:8 row_mask:0xf bank_mask:0xf
    v_dot2c_f32_bf16_dpp v10, v28, v73 row_newbcast:8 row_mask:0xf bank_mask:0xf
    v_dot2c_f32_bf16_dpp v11, v28, v75 row_newbcast:8 row_mask:0xf bank_mask:0xf
    v_dot2c_f32_bf16_dpp v12, v28, v76 row_newbcast:9 row_mask:0xf bank_mask:0xf
    v_dot2c_f32_bf16_dpp v13, v28, v78 row_newbcast:9 row_mask:0xf bank_mask:0xf
    v_dot2c_f32_bf16_dpp v14, v28, v77 row_newbcast:9 row_mask:0xf bank_mask:0xf
    v_dot2c_f32_bf16_dpp v15, v28, v79 row_newbcast:9 row_mask:0xf bank_mask:0xf
    v_dot2c_f32_bf16_dpp v8, v28, v80 row_newbcast:10 row_mask:0xf bank_mask:0xf
    v_dot2c_f32_bf16_dpp v9, v28, v82 row_newbcast:10 row_mask:0xf bank_mask:0xf
    v_dot2c_f32_bf16_dpp v10, v28, v81 row_newbcast:10 row_mask:0xf bank_mask:0xf
    v_dot2c_f32_bf16_dpp v11, v28, v83 row_newbcast:10 row_mask:0xf bank_mask:0xf
    v_dot2c_f32_bf16_dpp v12, v28, v84 row_newbcast:11 row_mask:0xf bank_mask:0xf
    v_dot2c_f32_bf16_dpp v13, v28, v86 row_newbcast:11 row_mask:0xf bank_mask:0xf
    v_dot2c_f32_bf16_dpp v14, v28, v85 row_newbcast:11 row_mask:0xf bank_mask:0xf
    v_dot2c_f32_bf16_dpp v15, v28, v87 row_newbcast:11 row_mask:0xf bank_mask:0xf
    v_dot2c_f32_bf16_dpp v8, v28, v88 row_newbcast:12 row_mask:0xf bank_mask:0xf
    v_dot2c_f32_bf16_dpp v9, v28, v90 row_newbcast:12 row_mask:0xf bank_mask:0xf
    v_dot2c_f32_bf16_dpp v10, v28, v89 row_newbcast:12 row_mask:0xf bank_mask:0xf
    v_dot2c_f32_bf16_dpp v11, v28, v91 row_newbcast:12 row_mask:0xf bank_mask:0xf
    v_dot2c_f32_bf16_dpp v12, v28, v92 row_newbcast:13 row_mask:0xf bank_mask:0xf
    v_dot2c_f32_bf16_dpp v13, v28, v94 row_newbcast:13 row_mask:0xf bank_mask:0xf
    v_dot2c_f32_bf16_dpp v14, v28, v93 row_newbcast:13 row_mask:0xf bank_mask:0xf
    v_dot2c_f32_bf16_dpp v15, v28, v95 row_newbcast:13 row_mask:0xf bank_mask:0xf
    v_dot2c_f32_bf16_dpp v8, v28, v96 row_newbcast:14 row_mask:0xf bank_mask:0xf
    v_dot2c_f32_bf16_dpp v9, v28, v98 row_newbcast:14 row_mask:0xf bank_mask:0xf
    v_dot2c_f32_bf16_dpp v10, v28, v97 row_newbcast:14 row_mask:0xf bank_mask:0xf
    v_dot2c_f32_bf16_dpp v11, v28, v99 row_newbcast:14 row_mask:0xf bank_mask:0xf
    v_dot2c_f32_bf16_dpp v12, v28, v100 row_newbcast:15 row_mask:0xf bank_mask:0xf
    v_dot2c_f32_bf16_dpp v13, v28, v102 row_newbcast:15 row_mask:0xf bank_mask:0xf
    v_dot2c_f32_bf16_dpp v14, v28, v101 row_newbcast:15 row_mask:0xf bank_mask:0xf
    v_dot2c_f32_bf16_dpp v15, v28, v103 row_newbcast:15 row_mask:0xf bank_mask:0xf
    v_add_f32 v8, v8, v12
    v_add_f32 v9, v9, v13
    v_add_f32 v10, v10, v14
    v_add_f32 v11, v11, v15
    s_nop 0
    v_permlane32_swap_b32 v8, v10
    v_permlane32_swap_b32 v9, v11
    v_add_f32 v8, v8, v10
    v_add_f32 v9, v9, v11
    s_nop 1
    v_permlane16_swap_b32 v8, v9
    v_add_f32 v8, v8, v9
    ds_write_b32 v29, v8 offset:20480
    s_waitcnt lgkmcnt(0)
    s_cmp_lg_u32 s72, 0
    s_cbranch_scc1 L_nobar0
    s_barrier
L_nobar0:
    ds_read_b32 v200, v3 offset:20480
    ds_read_b32 v201, v3 offset:20736
    ds_read_b32 v202, v3 offset:20992
    ds_read_b32 v203, v3 offset:21248
    s_waitcnt lgkmcnt(0)
    v_add_f32 v200, v200, v201
    v_add_f32 v202, v202, v203
    v_add_f32 v200, v200, v202
    v_min_u32 v200, 0xfffffffe, v200
    buffer_store_dword v200, v32, s[44:47], s83 offen sc1
    buffer_store_dword v200, v32, s[44:47], s85 offen sc1
L_o_next:
    s_cmp_eq_u32 s72, 0
    s_cbranch_scc1 L_fin
    s_mov_b32 s72, 0
    s_setprio 0
    s_mov_b32 s76, 0
L_owno:
    ds_read_b32 v200, v37 offset:2568
    ds_read_b32 v201, v37 offset:2576
    s_waitcnt lgkmcnt(0)
    v_min_u32 v200, v200, v201
    s_nop 0
    v_readfirstlane_b32 s84, v200
    s_cmp_ge_u32 s84, 4
    s_nop 3
    s_cbranch_scc1 L_owno_ok
    s_add_u32 s76, s76, 1
    s_cmp_gt_u32 s76, 480000
    s_cbranch_scc1 L_owno_ok
    s_sleep 2
    s_branch L_owno
L_owno_ok:
    s_branch L_o_pass
L_roleM:
    s_and_b32 s83, s3, 1
    s_mul_i32 s83, s83, 288
    v_mul_u32_u24 v31, 72, v34
    v_add_u32 v31, s83, v31
    s_movk_i32 s83, 9216
    v_mul_lo_u32 v30, v31, s83
    v_lshl_add_u32 v30, v35, 2, v30
    s_lshl_b32 s83, s71, 6
    s_mov_b32 s76, 0
L_trm:
    ds_read_b32 v200, v37 offset:2592
    s_waitcnt lgkmcnt(0)
    v_readfirstlane_b32 s90, v200
    s_cmp_lg_u32 s90, 0
    s_nop 3
    s_cbranch_scc1 L_trm_ok
    s_add_u32 s76, s76, 1
    s_cmp_gt_u32 s76, 480000
    s_cbranch_scc1 L_trm_ok
    s_sleep 8
    s_branch L_trm
L_trm_ok:
    buffer_load_dword v40, v30, s[52:55], s83 offen
    s_add_u32 s83, s83, 9216
    buffer_load_dword v41, v30, s[52:55], s83 offen
    s_add_u32 s83, s83, 9216
    buffer_load_dword v42, v30, s[52:55], s83 offen
    s_add_u32 s83, s83, 9216
    buffer_load_dword v43, v30, s[52:55], s83 offen
    s_add_u32 s83, s83, 9216
    buffer_load_dword v44, v30, s[52:55], s83 offen
    s_add_u32 s83, s83, 9216
    buffer_load_dword v45, v30, s[52:55], s83 offen
    s_add_u32 s83, s83, 9216
    buffer_load_dword v46, v30, s[52:55], s83 offen
    s_add_u32 s83, s83, 9216
    buffer_load_dword v47, v30, s[52:55], s83 offen
    s_add_u32 s83, s83, 9216
    buffer_load_dword v48, v30, s[52:55], s83 offen
    s_add_u32 s83, s83, 9216
    buffer_load_dword v49, v30, s[52:55], s83 offen
    s_add_u32 s83, s83, 9216
    buffer_load_dword v50, v30, s[52:55], s83 offen
    s_add_u32 s83, s83, 9216
    buffer_load_dword v51, v30, s[52:55], s83 offen
    s_add_u32 s83, s83, 9216
    buffer_load_dword v52, v30, s[52:55], s83 offen
    s_add_u32 s83, s83, 9216
    buffer_load_dword v53, v30, s[52:55], s83 offen
    s_add_u32 s83, s83, 9216
    buffer_load_dword v54, v30, s[52:55], s83 offen
    s_add_u32 s83, s83, 9216
    buffer_load_dword v55, v30, s[52:55], s83 offen
    s_add_u32 s83, s83, 9216
    buffer_load_dword v56, v30, s[52:55], s83 offen
    s_add_u32 s83, s83, 9216
    buffer_load_dword v57, v30, s[52:55], s83 offen
    s_add_u32 s83, s83, 9216
    buffer_load_dword v58, v30, s[52:55], s83 offen
    s_add_u32 s83, s83, 9216
    buffer_load_dword v59, v30, s[52:55], s83 offen
    s_add_u32 s83, s83, 9216
    buffer_load_dword v60, v30, s[52:55], s83 offen
    s_add_u32 s83, s83, 9216
    buffer_load_dword v61, v30, s[52:55], s83 offen
    s_add_u32 s83, s83, 9216
    buffer_load_dword v62, v30, s[52:55], s83 offen
    s_add_u32 s83, s83, 9216
    buffer_load_dword v63, v30, s[52:55], s83 offen
    s_add_u32 s83, s83, 9216
    s_waitcnt vmcnt(23)
    buffer_load_dword v64, v30, s[52:55], s83 offen
    s_add_u32 s83, s83, 9216
    s_waitcnt vmcnt(23)
    buffer_load_dword v65, v30, s[52:55], s83 offen
    s_add_u32 s83, s83, 9216
    s_waitcnt vmcnt(23)
    buffer_load_dword v66, v30, s[52:55], s83 offen
    s_add_u32 s83, s83, 9216
    s_waitcnt vmcnt(23)
    buffer_load_dword v67, v30, s[52:55], s83 offen
    s_add_u32 s83, s83, 9216
    s_waitcnt vmcnt(23)
    buffer_load_dword v68, v30, s[52:55], s83 offen
    s_add_u32 s83, s83, 9216
    s_waitcnt vmcnt(23)
    buffer_load_dword v69, v30, s[52:55], s83 offen
    s_add_u32 s83, s83, 9216
    s_waitcnt vmcnt(23)
    buffer_load_dword v70, v30, s[52:55], s83 offen
    s_add_u32 s83, s83, 9216
    s_waitcnt vmcnt(23)
    buffer_load_dword v71, v30, s[52:55], s83 offen
    s_add_u32 s83, s83, 9216
    s_waitcnt vmcnt(23)
    buffer_load_dword v72, v30, s[52:55], s83 offen
    s_add_u32 s83, s83, 9216
    s_waitcnt vmcnt(23)
    buffer_load_dword v73, v30, s[52:55], s83 offen
    s_add_u32 s83, s83, 9216
    s_waitcnt vmcnt(23)
    buffer_load_dword v74, v30, s[52:55], s83 offen
    s_add_u32 s83, s83, 9216
    s_waitcnt vmcnt(23)
    buffer_load_dword v75, v30, s[52:55], s83 offen
    s_add_u32 s83, s83, 9216
    s_waitcnt vmcnt(23)
    buffer_load_dword v76, v30, s[52:55], s83 offen
    s_add_u32 s83, s83, 9216
    s_waitcnt vmcnt(23)
    buffer_load_dword v77, v30, s[52:55], s83 offen
    s_add_u32 s83, s83, 9216
    s_waitcnt vmcnt(23)
    buffer_load_dword v78, v30, s[52:55], s83 offen
    s_add_u32 s83, s83, 9216
    s_waitcnt vmcnt(23)
    buffer_load_dword v79, v30, s[52:55], s83 offen
    s_add_u32 s83, s83, 9216
    s_waitcnt vmcnt(23)
    buffer_load_dword v80, v30, s[52:55], s83 offen
    s_add_u32 s83, s83, 9216
    s_waitcnt vmcnt(23)
    buffer_load_dword v81, v30, s[52:55], s83 offen
    s_add_u32 s83, s83, 9216
    s_waitcnt vmcnt(23)
    buffer_load_dword v82, v30, s[52:55], s83 offen
    s_add_u32 s83, s83, 9216
    s_waitcnt vmcnt(23)
    buffer_load_dword v83, v30, s[52:55], s83 offen
    s_add_u32 s83, s83, 9216
    s_waitcnt vmcnt(23)
    buffer_load_dword v84, v30, s[52:55], s83 offen
    s_add_u32 s83, s83, 9216
    s_waitcnt vmcnt(23)
    buffer_load_dword v85, v30, s[52:55], s83 offen
    s_add_u32 s83, s83, 9216
    s_waitcnt vmcnt(23)
    buffer_load_dword v86, v30, s[52:55], s83 offen
    s_add_u32 s83, s83, 9216
    s_waitcnt vmcnt(23)
    buffer_load_dword v87, v30, s[52:55], s83 offen
    s_add_u32 s83, s83, 9216
    s_waitcnt vmcnt(23)
    buffer_load_dword v88, v30, s[52:55], s83 offen
    s_add_u32 s83, s83, 9216
    s_waitcnt vmcnt(23)
    buffer_load_dword v89, v30, s[52:55], s83 offen
    s_add_u32 s83, s83, 9216
    s_waitcnt vmcnt(23)
    buffer_load_dword v90, v30, s[52:55], s83 offen
    s_add_u32 s83, s83, 9216
    s_waitcnt vmcnt(23)
    buffer_load_dword v91, v30, s[52:55], s83 offen
    s_add_u32 s83, s83, 9216
    s_waitcnt vmcnt(23)
    buffer_load_dword v92, v30, s[52:55], s83 offen
    s_add_u32 s83, s83, 9216
    s_waitcnt vmcnt(23)
    buffer_load_dword v93, v30, s[52:55], s83 offen
    s_add_u32 s83, s83, 9216
    s_waitcnt vmcnt(23)
    buffer_load_dword v94, v30, s[52:55], s83 offen
    s_add_u32 s83, s83, 9216
    s_waitcnt vmcnt(23)
    buffer_load_dword v95, v30, s[52:55], s83 offen
    s_add_u32 s83, s83, 9216
    s_waitcnt vmcnt(23)
    buffer_load_dword v96, v30, s[52:55], s83 offen
    s_add_u32 s83, s83, 9216
    s_waitcnt vmcnt(23)
    buffer_load_dword v97, v30, s[52:55], s83 offen
    s_add_u32 s83, s83, 9216
    s_waitcnt vmcnt(23)
    buffer_load_dword v98, v30, s[52:55], s83 offen
    s_add_u32 s83, s83, 9216
    s_waitcnt vmcnt(23)
    buffer_load_dword v99, v30, s[52:55], s83 offen
    s_add_u32 s83, s83, 9216
    s_waitcnt vmcnt(23)
    buffer_load_dword v100, v30, s[52:55], s83 offen
    s_add_u32 s83, s83, 9216
    s_waitcnt vmcnt(23)
    buffer_load_dword v101, v30, s[52:55], s83 offen
    s_add_u32 s83, s83, 9216
    s_waitcnt vmcnt(23)
    buffer_load_dword v102, v30, s[52:55], s83 offen
    s_add_u32 s83, s83, 9216
    s_waitcnt vmcnt(23)
    buffer_load_dword v103, v30, s[52:55], s83 offen
    s_add_u32 s83, s83, 9216
    s_waitcnt vmcnt(23)
    buffer_load_dword v104, v30, s[52:55], s83 offen
    s_add_u32 s83, s83, 9216
    s_waitcnt vmcnt(23)
    buffer_load_dword v105, v30, s[52:55], s83 offen
    s_add_u32 s83, s83, 9216
    s_waitcnt vmcnt(23)
    buffer_load_dword v106, v30, s[52:55], s83 offen
    s_add_u32 s83, s83, 9216
    s_waitcnt vmcnt(23)
    buffer_load_dword v107, v30, s[52:55], s83 offen
    s_add_u32 s83, s83, 9216
    s_waitcnt vmcnt(23)
    buffer_load_dword v108, v30, s[52:55], s83 offen
    s_add_u32 s83, s83, 9216
    s_waitcnt vmcnt(23)
    buffer_load_dword v109, v30, s[52:55], s83 offen
    s_add_u32 s83, s83, 9216
    s_waitcnt vmcnt(23)
    buffer_load_dword v110, v30, s[52:55], s83 offen
    s_add_u32 s83, s83, 9216
    s_waitcnt vmcnt(23)
    buffer_load_dword v111, v30, s[52:55], s83 offen
    v_lshl_add_u32 v31, v35, 1, v31
    v_lshlrev_b32 v31, 2, v31
    s_add_u32 s90, s8, 0
    s_add_u32 s91, s8, 4608
    s_add_u32 s92, s8, 9216
    s_add_u32 s93, s8, 13824
    s_mul_i32 s83, s88, 576
    v_add_u32 v29, s83, v1
    v_cmp_gt_u32 vcc, 36, v2
    s_nop 1
    v_cndmask_b32 v30, v36, v29, vcc
    v_add_u32 v28, 2304, v1
    v_cndmask_b32 v29, v28, v29, vcc
    v_lshrrev_b32 v28, 1, v29
    ds_read_b64 v[4:5], v28 offset:1280
    v_lshrrev_b32 v24, 5, v2
    v_lshl_add_u32 v25, v24, 3, v35
    v_and_b32 v25, 15, v25
    v_lshlrev_b32 v25, 3, v25
    v_lshl_add_u32 v24, v35, 1, v24
    v_lshlrev_b32 v24, 2, v24
    s_lshl_b32 s83, s88, 7
    v_add_u32 v24, s83, v24
    v_lshrrev_b32 v22, 5, v2
    v_and_b32 v23, 31, v2
    v_lshl_add_u32 v21, v23, 1, v22
    v_lshlrev_b32 v21, 2, v21
    v_mul_u32_u24 v22, 18432, v22
    v_lshl_add_u32 v22, v23, 2, v22
    v_mov_b32 v23, 0x3d372713
    s_mul_i32 s85, s71, 2304
    s_lshl_b32 s83, s88, 8
    s_add_u32 s85, s85, s83
    s_add_u32 s85, s85, 0x64000
    ds_read_u16 v163, v37 offset:1280
    s_waitcnt lgkmcnt(0)
    v_and_b32 v7, s79, v5
    v_lshlrev_b32 v6, 16, v5
    v_and_b32 v5, s79, v4
    v_lshlrev_b32 v4, 16, v4
    v_lshlrev_b32 v163, 16, v163
    v_cmp_gt_u32 vcc, 36, v2
    v_sub_f32 v160, 0, v163
    s_nop 0
    v_cndmask_b32 v4, 0, v4, vcc
    v_cndmask_b32 v5, 0, v5, vcc
    v_cndmask_b32 v6, 0, v6, vcc
    v_cndmask_b32 v7, 0, v7, vcc
    v_cndmask_b32 v160, 0, v160, vcc
    v_mov_b32 v161, v160
    v_lshrrev_b32 v162, 5, v2
    s_lshl_b32 s83, s88, 3
    v_lshl_add_u32 v162, v162, 2, s83
    s_waitcnt vmcnt(0)
    v_perm_b32 v26, v41, v40, s86
    v_perm_b32 v41, v41, v40, s87
    v_mov_b32 v40, v26
    v_perm_b32 v26, v43, v42, s86
    v_perm_b32 v43, v43, v42, s87
    v_mov_b32 v42, v26
    v_perm_b32 v26, v45, v44, s86
    v_perm_b32 v45, v45, v44, s87
    v_mov_b32 v44, v26
    v_perm_b32 v26, v47, v46, s86
    v_perm_b32 v47, v47, v46, s87
    v_mov_b32 v46, v26
    v_perm_b32 v26, v49, v48, s86
    v_perm_b32 v49, v49, v48, s87
    v_mov_b32 v48, v26
    v_perm_b32 v26, v51, v50, s86
    v_perm_b32 v51, v51, v50, s87
    v_mov_b32 v50, v26
    v_perm_b32 v26, v53, v52, s86
    v_perm_b32 v53, v53, v52, s87
    v_mov_b32 v52, v26
    v_perm_b32 v26, v55, v54, s86
    v_perm_b32 v55, v55, v54, s87
    v_mov_b32 v54, v26
    v_perm_b32 v26, v57, v56, s86
    v_perm_b32 v57, v57, v56, s87
    v_mov_b32 v56, v26
    v_perm_b32 v26, v59, v58, s86
    v_perm_b32 v59, v59, v58, s87
    v_mov_b32 v58, v26
    v_perm_b32 v26, v61, v60, s86
    v_perm_b32 v61, v61, v60, s87
    v_mov_b32 v60, v26
    v_perm_b32 v26, v63, v62, s86
    v_perm_b32 v63, v63, v62, s87
    v_mov_b32 v62, v26
    v_perm_b32 v26, v65, v64, s86
    v_perm_b32 v65, v65, v64, s87
    v_mov_b32 v64, v26
    v_perm_b32 v26, v67, v66, s86
    v_perm_b32 v67, v67, v66, s87
    v_mov_b32 v66, v26
    v_perm_b32 v26, v69, v68, s86
    v_perm_b32 v69, v69, v68, s87
    v_mov_b32 v68, v26
    v_perm_b32 v26, v71, v70, s86
    v_perm_b32 v71, v71, v70, s87
    v_mov_b32 v70, v26
    v_perm_b32 v26, v73, v72, s86
    v_perm_b32 v73, v73, v72, s87
    v_mov_b32 v72, v26
    v_perm_b32 v26, v75, v74, s86
    v_perm_b32 v75, v75, v74, s87
    v_mov_b32 v74, v26
    v_perm_b32 v26, v77, v76, s86
    v_perm_b32 v77, v77, v76, s87
    v_mov_b32 v76, v26
    v_perm_b32 v26, v79, v78, s86
    v_perm_b32 v79, v79, v78, s87
    v_mov_b32 v78, v26
    v_perm_b32 v26, v81, v80, s86
    v_perm_b32 v81, v81, v80, s87
    v_mov_b32 v80, v26
    v_perm_b32 v26, v83, v82, s86
    v_perm_b32 v83, v83, v82, s87
    v_mov_b32 v82, v26
    v_perm_b32 v26, v85, v84, s86
    v_perm_b32 v85, v85, v84, s87
    v_mov_b32 v84, v26
    v_perm_b32 v26, v87, v86, s86
    v_perm_b32 v87, v87, v86, s87
    v_mov_b32 v86, v26
    v_perm_b32 v26, v89, v88, s86
    v_perm_b32 v89, v89, v88, s87
    v_mov_b32 v88, v26
    v_perm_b32 v26, v91, v90, s86
    v_perm_b32 v91, v91, v90, s87
    v_mov_b32 v90, v26
    v_perm_b32 v26, v93, v92, s86
    v_perm_b32 v93, v93, v92, s87
    v_mov_b32 v92, v26
    v_perm_b32 v26, v95, v94, s86
    v_perm_b32 v95, v95, v94, s87
    v_mov_b32 v94, v26
    v_perm_b32 v26, v97, v96, s86
    v_perm_b32 v97, v97, v96, s87
    v_mov_b32 v96, v26
    v_perm_b32 v26, v99, v98, s86
    v_perm_b32 v99, v99, v98, s87
    v_mov_b32 v98, v26
    v_perm_b32 v26, v101, v100, s86
    v_perm_b32 v101, v101, v100, s87
    v_mov_b32 v100, v26
    v_perm_b32 v26, v103, v102, s86
    v_perm_b32 v103, v103, v102, s87
    v_mov_b32 v102, v26
    v_perm_b32 v26, v105, v104, s86
    v_perm_b32 v105, v105, v104, s87
    v_mov_b32 v104, v26
    v_perm_b32 v26, v107, v106, s86
    v_perm_b32 v107, v107, v106, s87
    v_mov_b32 v106, v26
    v_perm_b32 v26, v109, v108, s86
    v_perm_b32 v109, v109, v108, s87
    v_mov_b32 v108, v26
    v_perm_b32 v26, v111, v110, s86
    v_perm_b32 v111, v111, v110, s87
    v_mov_b32 v110, v26
    s_nop 1
L_m_pass:
    s_cmp_lg_u32 s72, 0
    s_cselect_b64 vcc, -1, 0
    v_cndmask_b32 v20, v21, v36, vcc
    v_mov_b32 v8, 0
    v_mov_b32 v9, 0
    v_mov_b32 v10, 0
    v_mov_b32 v11, 0
    v_mul_u32_u24 v26, 2304, v2
    s_mul_i32 s84, s88, 576
    s_add_u32 s84, s84, s8
    v_add_u32 v26, s84, v26
    s_and_b32 s84, s71, 3
    s_lshl_b32 s84, s84, 7
    v_add_u32 v26, s84, v26
    v_cmp_gt_u32 vcc, 8, v2
    s_nop 1
    v_cndmask_b32 v26, v36, v26, vcc
    s_mul_i32 s76, s72, 30000
    s_nop 0
L_m_l:
    buffer_load_dword v200, v26, s[44:47], 0 offen sc1
    s_waitcnt vmcnt(0)
    v_cmp_eq_u32 vcc, -1, v200
    s_bcnt1_i32_b64 s84, vcc
    s_cmp_le_u32 s84, 1
    s_nop 2
    s_cbranch_scc1 L_m_l_ok
    s_add_u32 s76, s76, 1
    s_cmp_gt_u32 s76, 30000
    s_cbranch_scc1 L_m_l_ok
    s_sleep 1
    s_branch L_m_l
L_m_l_ok:
    s_mul_i32 s76, s72, 30000
    s_nop 0
L_m_yo:
    buffer_load_dwordx4 v[200:203], v30, s[44:47], s90 offen offset:0 sc1
    buffer_load_dwordx4 v[204:207], v30, s[44:47], s90 offen offset:2304 sc1
    buffer_load_dwordx4 v[208:211], v30, s[44:47], s91 offen offset:0 sc1
    buffer_load_dwordx4 v[212:215], v30, s[44:47], s91 offen offset:2304 sc1
    buffer_load_dwordx4 v[216:219], v30, s[44:47], s92 offen offset:0 sc1
    buffer_load_dwordx4 v[220:223], v30, s[44:47], s92 offen offset:2304 sc1
    buffer_load_dwordx4 v[224:227], v30, s[44:47], s93 offen offset:0 sc1
    buffer_load_dwordx4 v[228:231], v30, s[44:47], s93 offen offset:2304 sc1
    s_waitcnt vmcnt(0)
    v_pk_add_f32 v[164:165], v[200:201], v[216:217]
    v_pk_add_f32 v[166:167], v[202:203], v[218:219]
    v_pk_add_f32 v[168:169], v[204:205], v[220:221]
    v_pk_add_f32 v[170:171], v[206:207], v[222:223]
    v_pk_add_f32 v[172:173], v[208:209], v[224:225]
    v_pk_add_f32 v[174:175], v[210:211], v[226:227]
    v_pk_add_f32 v[176:177], v[212:213], v[228:229]
    v_pk_add_f32 v[178:179], v[214:215], v[230:231]
    v_pk_add_f32 v[164:165], v[164:165], v[172:173]
    v_pk_add_f32 v[166:167], v[166:167], v[174:175]
    v_pk_add_f32 v[168:169], v[168:169], v[176:177]
    v_pk_add_f32 v[170:171], v[170:171], v[178:179]
    v_pk_add_f32 v[164:165], v[164:165], v[168:169]
    v_pk_add_f32 v[166:167], v[166:167], v[170:171]
    v_pk_add_f32 v[26:27], v[164:165], v[166:167]
    v_cmp_u_f32 vcc, v26, v27
    v_cvt_pk_bf16_f32 v168, v164, v165
    v_cvt_pk_bf16_f32 v169, v166, v167
    v_lshlrev_b32 v164, 16, v168
    v_and_b32 v165, s79, v168
    v_lshlrev_b32 v166, 16, v169
    s_nop 1
    s_cbranch_vccz L_m_yo_ok
    s_add_u32 s76, s76, 1
    s_cmp_lt_u32 s76, 64
    s_cbranch_scc1 L_m_yo
    v_max_u32 v26, v200, v201
    v_max3_u32 v26, v26, v202, v203
    v_max3_u32 v26, v26, v204, v205
    v_max3_u32 v26, v26, v206, v207
    v_max3_u32 v26, v26, v208, v209
    v_max3_u32 v26, v26, v210, v211
    v_max3_u32 v26, v26, v212, v213
    v_max3_u32 v26, v26, v214, v215
    v_max3_u32 v26, v26, v216, v217
    v_max3_u32 v26, v26, v218, v219
    v_max3_u32 v26, v26, v220, v221
    v_max3_u32 v26, v26, v222, v223
    v_max3_u32 v26, v26, v224, v225
    v_max3_u32 v26, v26, v226, v227
    v_max3_u32 v26, v26, v228, v229
    v_max3_u32 v26, v26, v230, v231
    v_cmp_eq_u32 vcc, -1, v26
    s_nop 4
    s_cbranch_vccz L_m_yo_ok
    s_cmp_le_u32 s76, 30000
    s_cbranch_scc1 L_m_yo
    s_nop 0
L_m_yo_ok:
    v_and_b32 v167, s79, v169
    v_pk_add_f32 v[164:165], v[164:165], v[4:5]
    v_pk_add_f32 v[166:167], v[166:167], v[6:7]
    v_cvt_pk_bf16_f32 v26, v164, v165
    v_cvt_pk_bf16_f32 v27, v166, v167
    v_lshlrev_b32 v200, 16, v26
    v_and_b32 v201, s79, v26
    v_lshlrev_b32 v202, 16, v27
    v_and_b32 v203, s79, v27
    ds_write_b128 v29, v[200:203] offset:24576
    v_pk_add_f32 v[164:165], v[200:201], v[160:161]
    v_pk_add_f32 v[166:167], v[202:203], v[160:161]
    v_pk_mul_f32 v[170:171], v[164:165], v[164:165]
    v_pk_add_f32 v[168:169], v[164:165], v[166:167]
    v_pk_fma_f32 v[170:171], v[166:167], v[166:167], v[170:171]
    v_add_f32 v26, v168, v169
    v_add_f32 v27, v170, v171
    s_nop 1
    v_permlane32_swap_b32 v26, v27
    v_add_f32 v26, v26, v27
    v_mov_b32 v27, v26
    s_nop 1
    v_permlane16_swap_b32 v26, v27
    v_add_f32 v26, v26, v27
    s_nop 1
    v_add_f32_dpp v26, v26, v26 quad_perm:[1,0,3,2] row_mask:0xf bank_mask:0xf
    s_nop 1
    v_add_f32_dpp v26, v26, v26 quad_perm:[2,3,0,1] row_mask:0xf bank_mask:0xf
    s_nop 1
    v_add_f32_dpp v26, v26, v26 row_half_mirror row_mask:0xf bank_mask:0xf
    s_nop 1
    v_add_f32_dpp v26, v26, v26 row_mirror row_mask:0xf bank_mask:0xf
    ds_write_b32 v162, v26 offset:30720
    s_waitcnt lgkmcnt(0)
    s_cmp_lg_u32 s72, 0
    s_cbranch_scc1 L_nobar1
    s_barrier
L_nobar1:
    ds_read_b128 v[164:167], v37 offset:30720
    ds_read_b128 v[168:171], v37 offset:30736
    ds_read_b64 v[210:211], v31 offset:24576
    ds_read_b64 v[212:213], v31 offset:24704
    ds_read_b64 v[214:215], v31 offset:24832
    s_waitcnt lgkmcnt(3)
    v_pk_add_f32 v[164:165], v[164:165], v[166:167]
    v_pk_add_f32 v[168:169], v[168:169], v[170:171]
    v_pk_add_f32 v[164:165], v[164:165], v[168:169]
    v_mul_f32 v164, 0x3ae38e39, v164
    v_mul_f32 v28, 0x3ae38e39, v165
    v_fma_f32 v28, -v164, v164, v28
    v_add_f32 v26, v164, v163
    v_max_f32 v28, 0, v28
    v_cvt_pk_bf16_f32 v26, v26, v26
    v_cvt_pk_bf16_f32 v28, v28, v28
    v_and_b32 v26, 0xffff0000, v26
    v_and_b32 v28, 0xffff0000, v28
    v_add_f32 v28, 0x3727c5ac, v28
    v_cvt_pk_bf16_f32 v28, v28, v28
    v_and_b32 v28, 0xffff0000, v28
    v_sqrt_f32 v28, v28
    s_waitcnt lgkmcnt(0)
    v_pk_add_f32 v[210:211], v[210:211], v[26:27] op_sel_hi:[1,0] neg_lo:[0,1] neg_hi:[0,1]
    v_pk_add_f32 v[212:213], v[212:213], v[26:27] op_sel_hi:[1,0] neg_lo:[0,1] neg_hi:[0,1]
    v_pk_add_f32 v[214:215], v[214:215], v[26:27] op_sel_hi:[1,0] neg_lo:[0,1] neg_hi:[0,1]
    v_cvt_pk_bf16_f32 v28, v28, v28
    v_and_b32 v28, 0xffff0000, v28
    v_rcp_f32 v28, v28
    v_cvt_pk_bf16_f32 v216, v210, v211
    v_cvt_pk_bf16_f32 v217, v212, v213
    v_cvt_pk_bf16_f32 v218, v214, v215
    v_lshlrev_b32 v210, 16, v216
    v_and_b32 v211, 0xffff0000, v216
    v_pk_mul_f32 v[210:211], v[210:211], v[28:29] op_sel_hi:[1,0]
    v_cvt_pk_bf16_f32 v216, v210, v211
    v_lshlrev_b32 v212, 16, v217
    v_and_b32 v213, 0xffff0000, v217
    v_pk_mul_f32 v[212:213], v[212:213], v[28:29] op_sel_hi:[1,0]
    v_cvt_pk_bf16_f32 v217, v212, v213
    v_lshlrev_b32 v214, 16, v218
    v_and_b32 v215, 0xffff0000, v218
    v_pk_mul_f32 v[214:215], v[214:215], v[28:29] op_sel_hi:[1,0]
    v_cvt_pk_bf16_f32 v218, v214, v215
    v_dot2c_f32_bf16_dpp v8, v216, v40 row_newbcast:0 row_mask:0xf bank_mask:0xf
    v_dot2c_f32_bf16_dpp v9, v216, v41 row_newbcast:0 row_mask:0xf bank_mask:0xf
    v_dot2c_f32_bf16_dpp v10, v216, v42 row_newbcast:1 row_mask:0xf bank_mask:0xf
    v_dot2c_f32_bf16_dpp v11, v216, v43 row_newbcast:1 row_mask:0xf bank_mask:0xf
    v_dot2c_f32_bf16_dpp v8, v216, v44 row_newbcast:2 row_mask:0xf bank_mask:0xf
    v_dot2c_f32_bf16_dpp v9, v216, v45 row_newbcast:2 row_mask:0xf bank_mask:0xf
    v_dot2c_f32_bf16_dpp v10, v216, v46 row_newbcast:3 row_mask:0xf bank_mask:0xf
    v_dot2c_f32_bf16_dpp v11, v216, v47 row_newbcast:3 row_mask:0xf bank_mask:0xf
    v_dot2c_f32_bf16_dpp v8, v216, v48 row_newbcast:4 row_mask:0xf bank_mask:0xf
    v_dot2c_f32_bf16_dpp v9, v216, v49 row_newbcast:4 row_mask:0xf bank_mask:0xf
    v_dot2c_f32_bf16_dpp v10, v216, v50 row_newbcast:5 row_mask:0xf bank_mask:0xf
    v_dot2c_f32_bf16_dpp v11, v216, v51 row_newbcast:5 row_mask:0xf bank_mask:0xf
    v_dot2c_f32_bf16_dpp v8, v216, v52 row_newbcast:6 row_mask:0xf bank_mask:0xf
    v_dot2c_f32_bf16_dpp v9, v216, v53 row_newbcast:6 row_mask:0xf bank_mask:0xf
    v_dot2c_f32_bf16_dpp v10, v216, v54 row_newbcast:7 row_mask:0xf bank_mask:0xf
    v_dot2c_f32_bf16_dpp v11, v216, v55 row_newbcast:7 row_mask:0xf bank_mask:0xf
    v_dot2c_f32_bf16_dpp v8, v216, v56 row_newbcast:8 row_mask:0xf bank_mask:0xf
    v_dot2c_f32_bf16_dpp v9, v216, v57 row_newbcast:8 row_mask:0xf bank_mask:0xf
    v_dot2c_f32_bf16_dpp v10, v216, v58 row_newbcast:9 row_mask:0xf bank_mask:0xf
    v_dot2c_f32_bf16_dpp v11, v216, v59 row_newbcast:9 row_mask:0xf bank_mask:0xf
    v_dot2c_f32_bf16_dpp v8, v216, v60 row_newbcast:10 row_mask:0xf bank_mask:0xf
    v_dot2c_f32_bf16_dpp v9, v216, v61 row_newbcast:10 row_mask:0xf bank_mask:0xf
    v_dot2c_f32_bf16_dpp v10, v216, v62 row_newbcast:11 row_mask:0xf bank_mask:0xf
    v_dot2c_f32_bf16_dpp v11, v216, v63 row_newbcast:11 row_mask:0xf bank_mask:0xf
    v_dot2c_f32_bf16_dpp v8, v216, v64 row_newbcast:12 row_mask:0xf bank_mask:0xf
    v_dot2c_f32_bf16_dpp v9, v216, v65 row_newbcast:12 row_mask:0xf bank_mask:0xf
    v_dot2c_f32_bf16_dpp v10, v216, v66 row_newbcast:13 row_mask:0xf bank_mask:0xf
    v_dot2c_f32_bf16_dpp v11, v216, v67 row_newbcast:13 row_mask:0xf bank_mask:0xf
    v_dot2c_f32_bf16_dpp v8, v216, v68 row_newbcast:14 row_mask:0xf bank_mask:0xf
    v_dot2c_f32_bf16_dpp v9, v216, v69 row_newbcast:14 row_mask:0xf bank_mask:0xf
    v_dot2c_f32_bf16_dpp v10, v216, v70 row_newbcast:15 row_mask:0xf bank_mask:0xf
    v_dot2c_f32_bf16_dpp v11, v216, v71 row_newbcast:15 row_mask:0xf bank_mask:0xf
    v_dot2c_f32_bf16_dpp v8, v217, v72 row_newbcast:0 row_mask:0xf bank_mask:0xf
    v_dot2c_f32_bf16_dpp v9, v217, v73 row_newbcast:0 row_mask:0xf bank_mask:0xf
    v_dot2c_f32_bf16_dpp v10, v217, v74 row_newbcast:1 row_mask:0xf bank_mask:0xf
    v_dot2c_f32_bf16_dpp v11, v217, v75 row_newbcast:1 row_mask:0xf bank_mask:0xf
    v_dot2c_f32_bf16_dpp v8, v217, v76 row_newbcast:2 row_mask:0xf bank_mask:0xf
    v_dot2c_f32_bf16_dpp v9, v217, v77 row_newbcast:2 row_mask:0xf bank_mask:0xf
    v_dot2c_f32_bf16_dpp v10, v217, v78 row_newbcast:3 row_mask:0xf bank_mask:0xf
    v_dot2c_f32_bf16_dpp v11, v217, v79 row_newbcast:3 row_mask:0xf bank_mask:0xf
    v_dot2c_f32_bf16_dpp v8, v217, v80 row_newbcast:4 row_mask:0xf bank_mask:0xf
    v_dot2c_f32_bf16_dpp v9, v217, v81 row_newbcast:4 row_mask:0xf bank_mask:0xf
    v_dot2c_f32_bf16_dpp v10, v217, v82 row_newbcast:5 row_mask:0xf bank_mask:0xf
    v_dot2c_f32_bf16_dpp v11, v217, v83 row_newbcast:5 row_mask:0xf bank_mask:0xf
    v_dot2c_f32_bf16_dpp v8, v217, v84 row_newbcast:6 row_mask:0xf bank_mask:0xf
    v_dot2c_f32_bf16_dpp v9, v217, v85 row_newbcast:6 row_mask:0xf bank_mask:0xf
    v_dot2c_f32_bf16_dpp v10, v217, v86 row_newbcast:7 row_mask:0xf bank_mask:0xf
    v_dot2c_f32_bf16_dpp v11, v217, v87 row_newbcast:7 row_mask:0xf bank_mask:0xf
    v_dot2c_f32_bf16_dpp v8, v217, v88 row_newbcast:8 row_mask:0xf bank_mask:0xf
    v_dot2c_f32_bf16_dpp v9, v217, v89 row_newbcast:8 row_mask:0xf bank_mask:0xf
    v_dot2c_f32_bf16_dpp v10, v217, v90 row_newbcast:9 row_mask:0xf bank_mask:0xf
    v_dot2c_f32_bf16_dpp v11, v217, v91 row_newbcast:9 row_mask:0xf bank_mask:0xf
    v_dot2c_f32_bf16_dpp v8, v217, v92 row_newbcast:10 row_mask:0xf bank_mask:0xf
    v_dot2c_f32_bf16_dpp v9, v217, v93 row_newbcast:10 row_mask:0xf bank_mask:0xf
    v_dot2c_f32_bf16_dpp v10, v217, v94 row_newbcast:11 row_mask:0xf bank_mask:0xf
    v_dot2c_f32_bf16_dpp v11, v217, v95 row_newbcast:11 row_mask:0xf bank_mask:0xf
    v_dot2c_f32_bf16_dpp v8, v217, v96 row_newbcast:12 row_mask:0xf bank_mask:0xf
    v_dot2c_f32_bf16_dpp v9, v217, v97 row_newbcast:12 row_mask:0xf bank_mask:0xf
    v_dot2c_f32_bf16_dpp v10, v217, v98 row_newbcast:13 row_mask:0xf bank_mask:0xf
    v_dot2c_f32_bf16_dpp v11, v217, v99 row_newbcast:13 row_mask:0xf bank_mask:0xf
    v_dot2c_f32_bf16_dpp v8, v217, v100 row_newbcast:14 row_mask:0xf bank_mask:0xf
    v_dot2c_f32_bf16_dpp v9, v217, v101 row_newbcast:14 row_mask:0xf bank_mask:0xf
    v_dot2c_f32_bf16_dpp v10, v217, v102 row_newbcast:15 row_mask:0xf bank_mask:0xf
    v_dot2c_f32_bf16_dpp v11, v217, v103 row_newbcast:15 row_mask:0xf bank_mask:0xf
    v_dot2c_f32_bf16_dpp v8, v218, v104 row_newbcast:0 row_mask:0xf bank_mask:0xf
    v_dot2c_f32_bf16_dpp v9, v218, v105 row_newbcast:0 row_mask:0xf bank_mask:0xf
    v_dot2c_f32_bf16_dpp v10, v218, v106 row_newbcast:1 row_mask:0xf bank_mask:0xf
    v_dot2c_f32_bf16_dpp v11, v218, v107 row_newbcast:1 row_mask:0xf bank_mask:0xf
    v_dot2c_f32_bf16_dpp v8, v218, v108 row_newbcast:2 row_mask:0xf bank_mask:0xf
    v_dot2c_f32_bf16_dpp v9, v218, v109 row_newbcast:2 row_mask:0xf bank_mask:0xf
    v_dot2c_f32_bf16_dpp v10, v218, v110 row_newbcast:3 row_mask:0xf bank_mask:0xf
    v_dot2c_f32_bf16_dpp v11, v218, v111 row_newbcast:3 row_mask:0xf bank_mask:0xf
    s_nop 1
    v_add_f32 v8, v8, v10
    v_add_f32 v9, v9, v11
    s_nop 1
    v_permlane32_swap_b32 v8, v9
    v_add_f32 v8, v8, v9
    v_mov_b32 v9, v8
    s_nop 1
    v_permlane16_swap_b32 v8, v9
    v_add_f32 v8, v8, v9
    ds_write_b32 v24, v8 offset:28672
    v_mov_b32 v8, 0
    v_mov_b32 v9, 0
    v_mov_b32 v10, 0
    v_mov_b32 v11, 0
    v_mov_b32 v12, 0
    v_mov_b32 v13, 0
    s_waitcnt lgkmcnt(0)
    s_cmp_lg_u32 s72, 0
    s_cbranch_scc1 L_nobar2
    s_barrier
L_nobar2:
    ds_read_b64 v[200:201], v25 offset:28672
    ds_read_b64 v[202:203], v25 offset:28800
    ds_read_b64 v[204:205], v25 offset:28928
    ds_read_b64 v[206:207], v25 offset:29056
    s_waitcnt lgkmcnt(0)
    v_add_f32 v200, v200, v202
    v_add_f32 v204, v204, v206
    v_add_f32 v201, v201, v203
    v_add_f32 v205, v205, v207
    v_cvt_pk_bf16_f32 v26, v200, v201
    v_cvt_pk_bf16_f32 v27, v204, v205
    v_lshlrev_b32 v200, 16, v26
    v_and_b32 v201, s79, v26
    v_lshlrev_b32 v204, 16, v27
    v_and_b32 v205, s79, v27
    v_mul_f32 v202, v200, v200
    v_mul_f32 v203, v201, v201
    v_mul_f32 v202, v202, v200
    v_mul_f32 v203, v203, v201
    v_fma_f32 v202, v202, v23, v200
    v_fma_f32 v203, v203, v23, v201
    v_mul_f32 v202, 0xc0135761, v202
    v_mul_f32 v203, 0xc0135761, v203
    v_exp_f32 v202, v202
    v_exp_f32 v203, v203
    v_add_f32 v202, 1.0, v202
    v_add_f32 v203, 1.0, v203
    v_rcp_f32 v202, v202
    v_rcp_f32 v203, v203
    v_mul_f32 v202, v202, v200
    v_mul_f32 v203, v203, v201
    v_cvt_pk_bf16_f32 v26, v202, v203
    v_lshlrev_b32 v202, 16, v26
    v_and_b32 v203, s79, v26
    v_mul_f32 v202, v202, v204
    v_mul_f32 v203, v203, v205
    v_cvt_pk_bf16_f32 v26, v202, v203
    s_nop 1
    v_dot2c_f32_bf16_dpp v8, v26, v112 row_newbcast:0 row_mask:0xf bank_mask:0xf
    v_dot2c_f32_bf16_dpp v9, v26, v113 row_newbcast:0 row_mask:0xf bank_mask:0xf
    v_dot2c_f32_bf16_dpp v10, v26, v128 row_newbcast:0 row_mask:0xf bank_mask:0xf
    v_dot2c_f32_bf16_dpp v11, v26, v129 row_newbcast:0 row_mask:0xf bank_mask:0xf
    v_dot2c_f32_bf16_dpp v8, v26, v114 row_newbcast:1 row_mask:0xf bank_mask:0xf
    v_dot2c_f32_bf16_dpp v9, v26, v115 row_newbcast:1 row_mask:0xf bank_mask:0xf
    v_dot2c_f32_bf16_dpp v10, v26, v130 row_newbcast:1 row_mask:0xf bank_mask:0xf
    v_dot2c_f32_bf16_dpp v11, v26, v131 row_newbcast:1 row_mask:0xf bank_mask:0xf
    v_dot2c_f32_bf16_dpp v8, v26, v116 row_newbcast:2 row_mask:0xf bank_mask:0xf
    v_dot2c_f32_bf16_dpp v9, v26, v117 row_newbcast:2 row_mask:0xf bank_mask:0xf
    v_dot2c_f32_bf16_dpp v10, v26, v132 row_newbcast:2 row_mask:0xf bank_mask:0xf
    v_dot2c_f32_bf16_dpp v11, v26, v133 row_newbcast:2 row_mask:0xf bank_mask:0xf
    v_dot2c_f32_bf16_dpp v8, v26, v118 row_newbcast:3 row_mask:0xf bank_mask:0xf
    v_dot2c_f32_bf16_dpp v9, v26, v119 row_newbcast:3 row_mask:0xf bank_mask:0xf
    v_dot2c_f32_bf16_dpp v10, v26, v134 row_newbcast:3 row_mask:0xf bank_mask:0xf
    v_dot2c_f32_bf16_dpp v11, v26, v135 row_newbcast:3 row_mask:0xf bank_mask:0xf
    v_dot2c_f32_bf16_dpp v8, v26, v120 row_newbcast:4 row_mask:0xf bank_mask:0xf
    v_dot2c_f32_bf16_dpp v9, v26, v121 row_newbcast:4 row_mask:0xf bank_mask:0xf
    v_dot2c_f32_bf16_dpp v10, v26, v136 row_newbcast:4 row_mask:0xf bank_mask:0xf
    v_dot2c_f32_bf16_dpp v11, v26, v137 row_newbcast:4 row_mask:0xf bank_mask:0xf
    v_dot2c_f32_bf16_dpp v8, v26, v122 row_newbcast:5 row_mask:0xf bank_mask:0xf
    v_dot2c_f32_bf16_dpp v9, v26, v123 row_newbcast:5 row_mask:0xf bank_mask:0xf
    v_dot2c_f32_bf16_dpp v10, v26, v138 row_newbcast:5 row_mask:0xf bank_mask:0xf
    v_dot2c_f32_bf16_dpp v11, v26, v139 row_newbcast:5 row_mask:0xf bank_mask:0xf
    v_dot2c_f32_bf16_dpp v8, v26, v124 row_newbcast:6 row_mask:0xf bank_mask:0xf
    v_dot2c_f32_bf16_dpp v9, v26, v125 row_newbcast:6 row_mask:0xf bank_mask:0xf
    v_dot2c_f32_bf16_dpp v10, v26, v140 row_newbcast:6 row_mask:0xf bank_mask:0xf
    v_dot2c_f32_bf16_dpp v11, v26, v141 row_newbcast:6 row_mask:0xf bank_mask:0xf
    v_dot2c_f32_bf16_dpp v8, v26, v126 row_newbcast:7 row_mask:0xf bank_mask:0xf
    v_dot2c_f32_bf16_dpp v9, v26, v127 row_newbcast:7 row_mask:0xf bank_mask:0xf
    v_dot2c_f32_bf16_dpp v10, v26, v142 row_newbcast:7 row_mask:0xf bank_mask:0xf
    v_dot2c_f32_bf16_dpp v11, v26, v143 row_newbcast:7 row_mask:0xf bank_mask:0xf
    s_nop 0
    v_permlane32_swap_b32 v8, v9
    s_nop 0
    v_permlane32_swap_b32 v10, v11
    v_add_f32 v8, v8, v9
    v_add_f32 v10, v10, v11
    v_min_u32 v8, 0xfffffffe, v8
    v_min_u32 v10, 0xfffffffe, v10
    buffer_store_dword v8, v20, s[44:47], s85 offen offset:0 sc1
    buffer_store_dword v10, v20, s[44:47], s85 offen offset:1024 sc1
    s_cmp_lg_u32 s3, 4
    s_cbranch_scc1 L_m_next
    v_mov_b32 v14, 0
    v_mov_b32 v15, 0
    v_dot2c_f32_bf16_dpp v12, v26, v144 row_newbcast:0 row_mask:0xf bank_mask:0xf
    v_dot2c_f32_bf16_dpp v13, v26, v145 row_newbcast:0 row_mask:0xf bank_mask:0xf
    v_dot2c_f32_bf16_dpp v14, v26, v146 row_newbcast:1 row_mask:0xf bank_mask:0xf
    v_dot2c_f32_bf16_dpp v15, v26, v147 row_newbcast:1 row_mask:0xf bank_mask:0xf
    v_dot2c_f32_bf16_dpp v12, v26, v148 row_newbcast:2 row_mask:0xf bank_mask:0xf
    v_dot2c_f32_bf16_dpp v13, v26, v149 row_newbcast:2 row_mask:0xf bank_mask:0xf
    v_dot2c_f32_bf16_dpp v14, v26, v150 row_newbcast:3 row_mask:0xf bank_mask:0xf
    v_dot2c_f32_bf16_dpp v15, v26, v151 row_newbcast:3 row_mask:0xf bank_mask:0xf
    v_dot2c_f32_bf16_dpp v12, v26, v152 row_newbcast:4 row_mask:0xf bank_mask:0xf
    v_dot2c_f32_bf16_dpp v13, v26, v153 row_newbcast:4 row_mask:0xf bank_mask:0xf
    v_dot2c_f32_bf16_dpp v14, v26, v154 row_newbcast:5 row_mask:0xf bank_mask:0xf
    v_dot2c_f32_bf16_dpp v15, v26, v155 row_newbcast:5 row_mask:0xf bank_mask:0xf
    v_dot2c_f32_bf16_dpp v12, v26, v156 row_newbcast:6 row_mask:0xf bank_mask:0xf
    v_dot2c_f32_bf16_dpp v13, v26, v157 row_newbcast:6 row_mask:0xf bank_mask:0xf
    v_dot2c_f32_bf16_dpp v14, v26, v158 row_newbcast:7 row_mask:0xf bank_mask:0xf
    v_dot2c_f32_bf16_dpp v15, v26, v159 row_newbcast:7 row_mask:0xf bank_mask:0xf
    s_nop 1
    v_add_f32 v12, v12, v14
    v_add_f32 v13, v13, v15
    s_nop 1
    v_permlane32_swap_b32 v12, v13
    v_add_f32 v12, v12, v13
    v_min_u32 v12, 0xfffffffe, v12
    buffer_store_dword v12, v20, s[44:47], s85 offen offset:2048 sc1
    s_nop 0
L_m_next:
    s_cmp_eq_u32 s72, 0
    s_cbranch_scc1 L_fin
    s_mov_b32 s72, 0
    s_setprio 0
    s_setprio 0
    s_mov_b32 s76, 0
L_ownm0:
    ds_read_b32 v200, v37 offset:2568
    ds_read_b32 v201, v37 offset:2576
    s_waitcnt lgkmcnt(0)
    v_min_u32 v200, v200, v201
    s_nop 0
    v_readfirstlane_b32 s84, v200
    s_cmp_ge_u32 s84, 4
    s_nop 3
    s_cbranch_scc1 L_ownm0_ok
    s_add_u32 s76, s76, 1
    s_cmp_gt_u32 s76, 480000
    s_cbranch_scc1 L_ownm0_ok
    s_sleep 2
    s_branch L_ownm0
L_ownm0_ok:
    s_sleep 4
    s_mul_i32 s84, s71, 36864
    s_lshl_b32 s83, s88, 7
    s_add_u32 s84, s84, s83
    s_add_u32 s83, s84, 0
    buffer_load_dword v112, v22, s[56:59], s83 offen offset:0 nt
    buffer_load_dword v113, v22, s[56:59], s83 offen offset:1152 nt
    buffer_load_dword v114, v22, s[56:59], s83 offen offset:2304 nt
    s_add_u32 s83, s83, 3456
    buffer_load_dword v115, v22, s[56:59], s83 offen offset:0 nt
    buffer_load_dword v116, v22, s[56:59], s83 offen offset:1152 nt
    buffer_load_dword v117, v22, s[56:59], s83 offen offset:2304 nt
    s_add_u32 s83, s83, 3456
    buffer_load_dword v118, v22, s[56:59], s83 offen offset:0 nt
    buffer_load_dword v119, v22, s[56:59], s83 offen offset:1152 nt
    buffer_load_dword v120, v22, s[56:59], s83 offen offset:2304 nt
    s_add_u32 s83, s83, 3456
    buffer_load_dword v121, v22, s[56:59], s83 offen offset:0 nt
    buffer_load_dword v122, v22, s[56:59], s83 offen offset:1152 nt
    buffer_load_dword v123, v22, s[56:59], s83 offen offset:2304 nt
    s_add_u32 s83, s83, 3456
    buffer_load_dword v124, v22, s[56:59], s83 offen offset:0 nt
    buffer_load_dword v125, v22, s[56:59], s83 offen offset:1152 nt
    buffer_load_dword v126, v22, s[56:59], s83 offen offset:2304 nt
    s_add_u32 s83, s83, 3456
    buffer_load_dword v127, v22, s[56:59], s83 offen offset:0 nt
    s_add_u32 s83, s84, 512
    buffer_load_dword v128, v22, s[56:59], s83 offen offset:0 nt
    buffer_load_dword v129, v22, s[56:59], s83 offen offset:1152 nt
    buffer_load_dword v130, v22, s[56:59], s83 offen offset:2304 nt
    s_add_u32 s83, s83, 3456
    buffer_load_dword v131, v22, s[56:59], s83 offen offset:0 nt
    buffer_load_dword v132, v22, s[56:59], s83 offen offset:1152 nt
    buffer_load_dword v133, v22, s[56:59], s83 offen offset:2304 nt
    s_add_u32 s83, s83, 3456
    buffer_load_dword v134, v22, s[56:59], s83 offen offset:0 nt
    buffer_load_dword v135, v22, s[56:59], s83 offen offset:1152 nt
    buffer_load_dword v136, v22, s[56:59], s83 offen offset:2304 nt
    s_add_u32 s83, s83, 3456
    buffer_load_dword v137, v22, s[56:59], s83 offen offset:0 nt
    buffer_load_dword v138, v22, s[56:59], s83 offen offset:1152 nt
    buffer_load_dword v139, v22, s[56:59], s83 offen offset:2304 nt
    s_add_u32 s83, s83, 3456
    buffer_load_dword v140, v22, s[56:59], s83 offen offset:0 nt
    buffer_load_dword v141, v22, s[56:59], s83 offen offset:1152 nt
    buffer_load_dword v142, v22, s[56:59], s83 offen offset:2304 nt
    s_add_u32 s83, s83, 3456
    buffer_load_dword v143, v22, s[56:59], s83 offen offset:0 nt
    s_cmp_lg_u32 s3, 4
    s_cbranch_scc1 L_m_nod
    s_add_u32 s83, s84, 1024
    buffer_load_dword v144, v22, s[56:59], s83 offen offset:0 nt
    buffer_load_dword v145, v22, s[56:59], s83 offen offset:1152 nt
    buffer_load_dword v146, v22, s[56:59], s83 offen offset:2304 nt
    s_add_u32 s83, s83, 3456
    buffer_load_dword v147, v22, s[56:59], s83 offen offset:0 nt
    buffer_load_dword v148, v22, s[56:59], s83 offen offset:1152 nt
    buffer_load_dword v149, v22, s[56:59], s83 offen offset:2304 nt
    s_add_u32 s83, s83, 3456
    buffer_load_dword v150, v22, s[56:59], s83 offen offset:0 nt
    buffer_load_dword v151, v22, s[56:59], s83 offen offset:1152 nt
    buffer_load_dword v152, v22, s[56:59], s83 offen offset:2304 nt
    s_add_u32 s83, s83, 3456
    buffer_load_dword v153, v22, s[56:59], s83 offen offset:0 nt
    buffer_load_dword v154, v22, s[56:59], s83 offen offset:1152 nt
    buffer_load_dword v155, v22, s[56:59], s83 offen offset:2304 nt
    s_add_u32 s83, s83, 3456
    buffer_load_dword v156, v22, s[56:59], s83 offen offset:0 nt
    buffer_load_dword v157, v22, s[56:59], s83 offen offset:1152 nt
    buffer_load_dword v158, v22, s[56:59], s83 offen offset:2304 nt
    s_add_u32 s83, s83, 3456
    buffer_load_dword v159, v22, s[56:59], s83 offen offset:0 nt
L_m_nod:
    s_setprio 0
    s_mov_b32 s76, 0
L_ownm:
    ds_read_b32 v200, v37 offset:2568
    ds_read_b32 v201, v37 offset:2576
    s_waitcnt lgkmcnt(0)
    v_min_u32 v200, v200, v201
    s_nop 0
    v_readfirstlane_b32 s84, v200
    s_cmp_ge_u32 s84, 4
    s_nop 3
    s_cbranch_scc1 L_ownm_ok
    s_add_u32 s76, s76, 1
    s_cmp_gt_u32 s76, 480000
    s_cbranch_scc1 L_ownm_ok
    s_sleep 2
    s_branch L_ownm
L_ownm_ok:
    s_waitcnt vmcnt(0)
    v_perm_b32 v26, v113, v112, s86
    v_perm_b32 v113, v113, v112, s87
    v_mov_b32 v112, v26
    v_perm_b32 v26, v115, v114, s86
    v_perm_b32 v115, v115, v114, s87
    v_mov_b32 v114, v26
    v_perm_b32 v26, v117, v116, s86
    v_perm_b32 v117, v117, v116, s87
    v_mov_b32 v116, v26
    v_perm_b32 v26, v119, v118, s86
    v_perm_b32 v119, v119, v118, s87
    v_mov_b32 v118, v26
    v_perm_b32 v26, v121, v120, s86
    v_perm_b32 v121, v121, v120, s87
    v_mov_b32 v120, v26
    v_perm_b32 v26, v123, v122, s86
    v_perm_b32 v123, v123, v122, s87
    v_mov_b32 v122, v26
    v_perm_b32 v26, v125, v124, s86
    v_perm_b32 v125, v125, v124, s87
    v_mov_b32 v124, v26
    v_perm_b32 v26, v127, v126, s86
    v_perm_b32 v127, v127, v126, s87
    v_mov_b32 v126, v26
    v_perm_b32 v26, v129, v128, s86
    v_perm_b32 v129, v129, v128, s87
    v_mov_b32 v128, v26
    v_perm_b32 v26, v131, v130, s86
    v_perm_b32 v131, v131, v130, s87
    v_mov_b32 v130, v26
    v_perm_b32 v26, v133, v132, s86
    v_perm_b32 v133, v133, v132, s87
    v_mov_b32 v132, v26
    v_perm_b32 v26, v135, v134, s86
    v_perm_b32 v135, v135, v134, s87
    v_mov_b32 v134, v26
    v_perm_b32 v26, v137, v136, s86
    v_perm_b32 v137, v137, v136, s87
    v_mov_b32 v136, v26
    v_perm_b32 v26, v139, v138, s86
    v_perm_b32 v139, v139, v138, s87
    v_mov_b32 v138, v26
    v_perm_b32 v26, v141, v140, s86
    v_perm_b32 v141, v141, v140, s87
    v_mov_b32 v140, v26
    v_perm_b32 v26, v143, v142, s86
    v_perm_b32 v143, v143, v142, s87
    v_mov_b32 v142, v26
    v_perm_b32 v26, v145, v144, s86
    v_perm_b32 v145, v145, v144, s87
    v_mov_b32 v144, v26
    v_perm_b32 v26, v147, v146, s86
    v_perm_b32 v147, v147, v146, s87
    v_mov_b32 v146, v26
    v_perm_b32 v26, v149, v148, s86
    v_perm_b32 v149, v149, v148, s87
    v_mov_b32 v148, v26
    v_perm_b32 v26, v151, v150, s86
    v_perm_b32 v151, v151, v150, s87
    v_mov_b32 v150, v26
    v_perm_b32 v26, v153, v152, s86
    v_perm_b32 v153, v153, v152, s87
    v_mov_b32 v152, v26
    v_perm_b32 v26, v155, v154, s86
    v_perm_b32 v155, v155, v154, s87
    v_mov_b32 v154, v26
    v_perm_b32 v26, v157, v156, s86
    v_perm_b32 v157, v157, v156, s87
    v_mov_b32 v156, v26
    v_perm_b32 v26, v159, v158, s86
    v_perm_b32 v159, v159, v158, s87
    v_mov_b32 v158, v26
    s_nop 1
    s_branch L_m_pass
L_roleF:
    s_add_u32 s90, s8, 0
    s_add_u32 s91, s8, 4608
    s_add_u32 s92, s8, 9216
    s_add_u32 s93, s8, 13824
    s_lshl_b32 s83, s71, 6
    v_lshlrev_b32 v30, 2, v35
    v_add_u32 v30, s83, v30
    v_lshrrev_b32 v29, 1, v30
    ds_read_u16 v4, v29 offset:1280
    v_cmp_gt_u32 vcc, 16, v2
    s_nop 1
    v_cndmask_b32 v29, v36, v29, vcc
    v_and_b32 v22, 255, v0
    v_lshrrev_b32 v31, 2, v22
    v_mul_u32_u24 v31, 2304, v31
    v_and_b32 v24, 3, v0
    v_lshl_add_u32 v31, v24, 4, v31
    v_add_u32 v31, s83, v31
    v_cmp_gt_u32 vcc, 64, v22
    s_nop 1
    v_cndmask_b32 v32, v36, v31, vcc
    s_mov_b32 s94, 0x64000
    s_mov_b32 s95, 0x88000
    s_mov_b32 s96, 0xac000
    v_lshlrev_b32 v24, 4, v24
    v_lshl_add_u32 v24, v34, 2, v24
    s_lshl_b32 s83, s88, 6
    v_add_u32 v24, s83, v24
    v_lshlrev_b32 v25, 2, v35
    s_waitcnt lgkmcnt(0)
    v_lshlrev_b32 v4, 16, v4
    s_nop 1
L_f_pass:
    s_cmp_lg_u32 s72, 0
    s_cselect_b64 vcc, -1, 0
    v_cndmask_b32 v20, v29, v36, vcc
    s_mul_i32 s76, s72, 30000
    s_nop 0
L_f_yo:
    buffer_load_dword v200, v30, s[44:47], s90 offen offset:0 sc1
    buffer_load_dword v201, v30, s[44:47], s90 offen offset:2304 sc1
    buffer_load_dword v202, v30, s[44:47], s91 offen offset:0 sc1
    buffer_load_dword v203, v30, s[44:47], s91 offen offset:2304 sc1
    buffer_load_dword v204, v30, s[44:47], s92 offen offset:0 sc1
    buffer_load_dword v205, v30, s[44:47], s92 offen offset:2304 sc1
    buffer_load_dword v206, v30, s[44:47], s93 offen offset:0 sc1
    buffer_load_dword v207, v30, s[44:47], s93 offen offset:2304 sc1
    s_waitcnt vmcnt(0)
    v_max_u32 v26, v200, v201
    v_max3_u32 v26, v26, v202, v203
    v_max3_u32 v26, v26, v204, v205
    v_max3_u32 v26, v26, v206, v207
    v_cmp_eq_u32 vcc, -1, v26
    s_nop 4
    s_cbranch_vccz L_f_yo_ok
    s_add_u32 s76, s76, 1
    s_cmp_gt_u32 s76, 30000
    s_cbranch_scc1 L_f_yo_ok
    s_sleep 1
    s_branch L_f_yo
L_f_yo_ok:
    s_sleep 48
    v_add_f32 v200, v200, v204
    v_add_f32 v201, v201, v205
    v_add_f32 v202, v202, v206
    v_add_f32 v203, v203, v207
    v_add_f32 v200, v200, v202
    v_add_f32 v201, v201, v203
    v_add_f32 v200, v200, v201
    v_cvt_pk_bf16_f32 v200, v200, v200
    v_and_b32 v200, 0xffff0000, v200
    v_add_f32 v28, v4, v200
    v_cvt_pk_bf16_f32 v28, v28, v28
    v_and_b32 v28, 0xffff0000, v28
    s_mul_i32 s76, s72, 30000
    s_nop 0
L_f_yd:
    buffer_load_dwordx4 v[204:207], v31, s[44:47], s94 offen sc1
    buffer_load_dwordx4 v[208:211], v31, s[44:47], s95 offen sc1
    buffer_load_dwordx4 v[212:215], v32, s[44:47], s96 offen sc1
    s_waitcnt vmcnt(1)
    v_pk_add_f32 v[200:201], v[204:205], v[208:209]
    v_pk_add_f32 v[202:203], v[206:207], v[210:211]
    s_waitcnt vmcnt(0)
    v_pk_add_f32 v[200:201], v[200:201], v[212:213]
    v_pk_add_f32 v[202:203], v[202:203], v[214:215]
    v_pk_add_f32 v[26:27], v[200:201], v[202:203]
    v_cmp_u_f32 vcc, v26, v27
    v_add_f32_dpp v200, v200, v200 row_ror:4 row_mask:0xf bank_mask:0xf
    v_add_f32_dpp v201, v201, v201 row_ror:4 row_mask:0xf bank_mask:0xf
    v_add_f32_dpp v202, v202, v202 row_ror:4 row_mask:0xf bank_mask:0xf
    v_add_f32_dpp v203, v203, v203 row_ror:4 row_mask:0xf bank_mask:0xf
    s_nop 1
    s_cbranch_vccz L_f_yd_ok
    s_add_u32 s76, s76, 1
    s_cmp_lt_u32 s76, 64
    s_cbranch_scc1 L_f_yd
    v_max_u32 v26, v204, v205
    v_max3_u32 v26, v26, v206, v207
    v_max3_u32 v26, v26, v208, v209
    v_max3_u32 v26, v26, v210, v211
    v_max3_u32 v26, v26, v212, v213
    v_max3_u32 v26, v26, v214, v215
    v_cmp_eq_u32 vcc, -1, v26
    s_nop 4
    s_cbranch_vccz L_f_yd_ok
    s_cmp_le_u32 s76, 30000
    s_cbranch_scc1 L_f_yd
L_f_yd_ok:
    v_add_f32_dpp v200, v200, v200 row_ror:8 row_mask:0xf bank_mask:0xf
    v_add_f32_dpp v201, v201, v201 row_ror:8 row_mask:0xf bank_mask:0xf
    v_add_f32_dpp v202, v202, v202 row_ror:8 row_mask:0xf bank_mask:0xf
    v_add_f32_dpp v203, v203, v203 row_ror:8 row_mask:0xf bank_mask:0xf
    s_nop 0
    v_permlane32_swap_b32 v200, v202
    v_permlane32_swap_b32 v201, v203
    v_add_f32 v200, v200, v202
    v_add_f32 v201, v201, v203
    s_nop 1
    v_permlane16_swap_b32 v200, v201
    v_add_f32 v200, v200, v201
    ds_write_b32 v24, v200 offset:30720
    s_waitcnt lgkmcnt(0)
    s_cmp_lg_u32 s72, 0
    s_cbranch_scc1 L_nobar3
    s_barrier
L_nobar3:
    s_cmp_lg_u32 s3, 4
    s_cbranch_scc1 L_f_next
    ds_read_b32 v200, v25 offset:30720
    ds_read_b32 v201, v25 offset:30784
    ds_read_b32 v202, v25 offset:30848
    ds_read_b32 v203, v25 offset:30912
    s_waitcnt lgkmcnt(0)
    v_add_f32 v200, v200, v201
    v_add_f32 v202, v202, v203
    v_add_f32 v200, v200, v202
    v_cvt_pk_bf16_f32 v200, v200, v200
    v_and_b32 v200, 0xffff0000, v200
    v_add_f32 v28, v28, v200
    v_cvt_pk_bf16_f32 v28, v28, v28
    buffer_store_short v28, v20, s[60:63], 0 offen
    s_or_b32 s83, s71, s72
    s_cmp_lg_u32 s83, 0
    s_cbranch_scc1 L_f_notag
    v_mov_b32 v200, s98
    v_mov_b32 v201, s99
    s_mov_b32 s83, 0xf8000
    buffer_store_dwordx2 v[200:201], v37, s[44:47], s83 offen
L_f_notag:
L_f_next:
    s_cmp_eq_u32 s72, 0
    s_cbranch_scc1 L_fin
    s_mov_b32 s72, 0
    s_setprio 0
    s_mov_b32 s76, 0
L_ownf:
    ds_read_b32 v200, v37 offset:2568
    ds_read_b32 v201, v37 offset:2576
    s_waitcnt lgkmcnt(0)
    v_min_u32 v200, v200, v201
    s_nop 0
    v_readfirstlane_b32 s84, v200
    s_cmp_ge_u32 s84, 4
    s_nop 3
    s_cbranch_scc1 L_ownf_ok
    s_add_u32 s76, s76, 1
    s_cmp_gt_u32 s76, 480000
    s_cbranch_scc1 L_ownf_ok
    s_sleep 2
    s_branch L_ownf
L_ownf_ok:
    s_branch L_f_pass
L_fin:
L_end:
    s_endpgm
.section .rodata,"a"
.p2align 6
.amdhsa_kernel sequential_preLN__mha_block_cached__glu_gated_geglu__decode_kernel
  .amdhsa_next_free_vgpr 240
  .amdhsa_next_free_sgpr 102
  .amdhsa_accum_offset 240
  .amdhsa_group_segment_fixed_size 0
  .amdhsa_kernarg_size 96
  .amdhsa_user_sgpr_count 2
  .amdhsa_user_sgpr_kernarg_segment_ptr 1
  .amdhsa_system_sgpr_workgroup_id_x 1
  .amdhsa_float_denorm_mode_32 3
  .amdhsa_float_denorm_mode_16_64 3
.end_amdhsa_kernel
```
